```python
import torch

def _softmax(x, axis=-1):
    return torch.softmax(x, dim=axis)
def _gelu(x):
    return torch.nn.functional.gelu(x, approximate="tanh")
def _silu(x):
    return torch.nn.functional.silu(x)
def _sigmoid(x):
    return torch.sigmoid(x)
def _layernorm(x, axis=-1, eps=1e-5):
    m = x.mean(dim=axis, keepdim=True)
    v = x.var(dim=axis, keepdim=True, unbiased=False)
    return (x - m) / torch.sqrt(v + eps)
def _scatter_add(tgt, idx, src, axis=0):
    return tgt.clone().index_add_(axis, idx, src)
def _segment_sum(src, seg, n):
    out = torch.zeros((n,) + src.shape[1:], dtype=src.dtype)
    return out.index_add_(0, seg, src)
def _pad(x, pw):
    flat = tuple(v for pair in reversed(pw) for v in pair)
    return torch.nn.functional.pad(x, flat)

kernel_name = 'standalone__swiglu_ffn__prompt'

def setup_inputs():

    _w = (lambda a: (lambda t: t.to(torch.bfloat16) if t.is_floating_point() else t)(torch.as_tensor(a)))
    B, S, D, F = 1, 2048, 512, 1376
    return {
        "x": _w((lambda *s: torch.randn(*s, dtype=torch.bfloat16) * 0.05)(B, S, D)),
        "w_gate": _w((lambda *s: torch.randn(*s, dtype=torch.bfloat16) * 0.05)(D, F)),
        "w_up": _w((lambda *s: torch.randn(*s, dtype=torch.bfloat16) * 0.05)(D, F)),
        "w_down": _w((lambda *s: torch.randn(*s, dtype=torch.bfloat16) * 0.05)(F, D)),
    }

def reference(x, w_gate, w_up, w_down):
    g = _silu(x @ w_gate)
    u = x @ w_up
    return (g * u) @ w_down
```

```asm
; @launch grid=(256,1,1) block=(512,1,1) lds=163840
.amdgcn_target "amdgcn-amd-amdhsa--gfx950"
.text
.globl standalone__swiglu_ffn__prompt_kernel
.p2align 8
.type standalone__swiglu_ffn__prompt_kernel,@function
standalone__swiglu_ffn__prompt_kernel:
    s_cmp_ge_u32 s2, 256
    s_cbranch_scc1 L_end
    s_load_dwordx8 s[4:11], s[0:1], 0
    s_load_dwordx4 s[12:15], s[0:1], 32
    s_load_dwordx2 s[16:17], s[0:1], 48
    v_lshrrev_b32 v2, 6, v0
    v_and_b32 v1, 63, v0
    s_and_b32 s53, s2, 7
    v_readfirstlane_b32 s50, v2
    s_lshr_b32 s54, s2, 3
    s_and_b32 s48, s53, 1
    s_lshl_b32 s48, s48, 3
    s_and_b32 s55, s54, 7
    s_add_u32 s48, s48, s55
    s_lshr_b32 s49, s53, 1
    s_lshl_b32 s49, s49, 2
    s_lshr_b32 s55, s54, 3
    s_add_u32 s49, s49, s55
    s_lshl_b32 s51, s53, 2
    s_and_b32 s55, s54, 3
    s_add_u32 s51, s51, s55
    s_lshr_b32 s52, s54, 2
    s_cmp_ge_u32 s50, 4
    s_cbranch_scc1 L_loader
    s_waitcnt lgkmcnt(0)
    s_mov_b32 s20, s4
    s_and_b32 s21, s5, 0xffff
    s_mov_b32 s22, 2097152
    s_mov_b32 s23, 0x00020000
    s_mov_b32 s24, s6
    s_and_b32 s25, s7, 0xffff
    s_mov_b32 s26, 1409024
    s_mov_b32 s27, 0x00020000
    s_mov_b32 s28, s8
    s_and_b32 s29, s9, 0xffff
    s_mov_b32 s30, 1409024
    s_mov_b32 s31, 0x00020000
    s_mov_b32 s32, s10
    s_and_b32 s33, s11, 0xffff
    s_mov_b32 s34, 1409024
    s_mov_b32 s35, 0x00020000
    s_lshl_b32 s56, s2, 2
    s_add_u32 s56, s56, s50
    s_lshl_b32 s57, s56, 11
    s_mul_i32 s58, s56, 1376
    v_lshlrev_b32 v3, 4, v1
    s_mov_b32 s59, 352
    v_cmp_gt_u32 s[60:61], s59, v3
    buffer_load_dwordx4 v[8:11], v3, s[20:23], s57 offen
    buffer_load_dwordx4 v[12:15], v3, s[20:23], s57 offen offset:1024
    buffer_load_dwordx4 v[16:19], v3, s[24:27], s58 offen
    buffer_load_dwordx4 v[16:19], v3, s[28:31], s58 offen
    s_and_saveexec_b64 s[62:63], s[60:61]
    buffer_load_dwordx4 v[20:23], v3, s[24:27], s58 offen offset:1024
    buffer_load_dwordx4 v[20:23], v3, s[28:31], s58 offen offset:1024
    s_mov_b64 exec, s[62:63]
    s_waitcnt lgkmcnt(0)
    s_mov_b32 s44, s14
    s_and_b32 s45, s15, 0xffff
    s_mov_b32 s46, 256
    s_mov_b32 s47, 0x00020000
    s_or_b32 s56, s2, s50
    s_cmp_lg_u32 s56, 0
    s_cbranch_scc1 C_nononce
    s_memrealtime s[56:57]
    s_waitcnt lgkmcnt(0)
    s_or_b32 s56, s56, 1
    v_mov_b32 v4, s56
    v_mov_b32 v5, s57
    v_mov_b32 v6, 0
    s_mov_b64 exec, 1
    buffer_store_dwordx2 v[4:5], v6, s[44:47], 0 offen sc1
    s_mov_b64 exec, -1
C_nononce:
    v_mov_b32 v248, 0
    s_cmp_ge_u32 s49, 15
    s_cbranch_scc1 C_p2
    s_and_b32 s56, s50, 1
    s_lshr_b32 s57, s50, 1
    v_and_b32 v3, 31, v1
    s_lshl_b32 s58, s56, 6
    v_add_u32 v3, s58, v3
    v_lshlrev_b32 v3, 7, v3
    v_lshrrev_b32 v4, 5, v1
    v_bfe_u32 v5, v1, 1, 3
    v_xor_b32 v4, v4, v5
    v_xor_b32 v6, 0, v4
    v_lshl_add_u32 v72, v6, 4, v3
    v_add_u32 v88, 81920, v72
    v_xor_b32 v6, 2, v4
    v_lshl_add_u32 v73, v6, 4, v3
    v_add_u32 v89, 81920, v73
    v_xor_b32 v6, 4, v4
    v_lshl_add_u32 v74, v6, 4, v3
    v_add_u32 v90, 81920, v74
    v_xor_b32 v6, 6, v4
    v_lshl_add_u32 v75, v6, 4, v3
    v_add_u32 v91, 81920, v75
    v_bfe_u32 v3, v1, 4, 1
    v_lshrrev_b32 v4, 5, v1
    v_bfe_u32 v5, v1, 2, 2
    v_lshl_add_u32 v4, v4, 3, v5
    v_mul_u32_u24 v4, 192, v4
    v_and_b32 v5, 3, v1
    v_lshl_add_u32 v4, v5, 3, v4
    v_mul_u32_u24 v5, 12288, v3
    v_add_u32 v4, v4, v5
    v_add_u32 v4, 16384, v4
    s_mul_i32 s58, s57, 3
    s_add_u32 s59, s58, 0
    v_xor_b32 v5, s59, v3
    v_lshl_add_u32 v76, v5, 5, v4
    v_add_u32 v92, 81920, v76
    s_add_u32 s59, s58, 1
    v_xor_b32 v5, s59, v3
    v_lshl_add_u32 v77, v5, 5, v4
    v_add_u32 v93, 81920, v77
    s_add_u32 s59, s58, 2
    v_xor_b32 v5, s59, v3
    v_lshl_add_u32 v78, v5, 5, v4
    v_add_u32 v94, 81920, v78
    s_waitcnt lgkmcnt(0)
    s_mov_b32 s40, s16
    s_and_b32 s41, s17, 0xffff
    s_mov_b32 s42, 16777216
    s_mov_b32 s43, 0x00020000
    s_mov_b32 s44, s14
    s_and_b32 s45, s15, 0xffff
    s_mov_b32 s46, 256
    s_mov_b32 s47, 0x00020000
    s_lshl_b32 s58, s48, 2
    s_lshl_b32 s59, s56, 1
    s_add_u32 s58, s58, s59
    s_mul_i32 s58, s58, 86
    s_mul_i32 s59, s49, 6
    s_mul_i32 s60, s57, 3
    s_add_u32 s59, s59, s60
    s_add_u32 s58, s58, s59
    s_lshl_b32 s58, s58, 10
    v_lshlrev_b32 v3, 4, v1
    v_add_u32 v3, s58, v3
    v_add_u32 v4, 88064, v3
    s_add_u32 s60, s59, 0
    s_cmp_ge_u32 s60, 86
    s_cselect_b32 s53, 0x40000000, 0
    s_add_u32 s60, s59, 1
    s_cmp_ge_u32 s60, 86
    s_cselect_b32 s54, 0x40000000, 1024
    s_add_u32 s60, s59, 2
    s_cmp_ge_u32 s60, 86
    s_cselect_b32 s55, 0x40000000, 2048
    s_mov_b32 s61, 0xbfb8aa3b
    v_mov_b32 v244, s61
    v_mov_b32 v245, s61
    s_barrier
    ds_read_b128 v[32:35], v72 offset:0
    ds_read_b64_tr_b16 v[40:41], v76 offset:0
    ds_read_b64_tr_b16 v[42:43], v76 offset:768
    ds_read_b128 v[36:39], v72 offset:4096
    ds_read_b64_tr_b16 v[44:45], v77 offset:0
    ds_read_b64_tr_b16 v[46:47], v77 offset:768
    ds_read_b64_tr_b16 v[48:49], v78 offset:0
    ds_read_b64_tr_b16 v[50:51], v78 offset:768
    s_waitcnt lgkmcnt(5)
    v_mfma_f32_32x32x16_bf16 v[128:143], v[40:43], v[32:35], 0
    ds_read_b128 v[52:55], v73 offset:0
    ds_read_b64_tr_b16 v[60:61], v76 offset:3072
    ds_read_b64_tr_b16 v[62:63], v76 offset:3840
    s_waitcnt lgkmcnt(7)
    v_mfma_f32_32x32x16_bf16 v[176:191], v[40:43], v[36:39], 0
    ds_read_b128 v[56:59], v73 offset:4096
    ds_read_b64_tr_b16 v[64:65], v77 offset:3072
    ds_read_b64_tr_b16 v[66:67], v77 offset:3840
    s_waitcnt lgkmcnt(8)
    v_mfma_f32_32x32x16_bf16 v[144:159], v[44:47], v[32:35], 0
    ds_read_b64_tr_b16 v[68:69], v78 offset:3072
    ds_read_b64_tr_b16 v[70:71], v78 offset:3840
    v_mfma_f32_32x32x16_bf16 v[192:207], v[44:47], v[36:39], 0
    s_waitcnt lgkmcnt(8)
    v_mfma_f32_32x32x16_bf16 v[160:175], v[48:51], v[32:35], 0
    v_mfma_f32_32x32x16_bf16 v[208:223], v[48:51], v[36:39], 0
    s_waitcnt lgkmcnt(5)
    v_mfma_f32_32x32x16_bf16 v[128:143], v[60:63], v[52:55], v[128:143]
    ds_read_b128 v[32:35], v74 offset:0
    ds_read_b64_tr_b16 v[40:41], v76 offset:6144
    ds_read_b64_tr_b16 v[42:43], v76 offset:6912
    s_waitcnt lgkmcnt(7)
    v_mfma_f32_32x32x16_bf16 v[176:191], v[60:63], v[56:59], v[176:191]
    ds_read_b128 v[36:39], v74 offset:4096
    ds_read_b64_tr_b16 v[44:45], v77 offset:6144
    ds_read_b64_tr_b16 v[46:47], v77 offset:6912
    s_waitcnt lgkmcnt(8)
    v_mfma_f32_32x32x16_bf16 v[144:159], v[64:67], v[52:55], v[144:159]
    ds_read_b64_tr_b16 v[48:49], v78 offset:6144
    ds_read_b64_tr_b16 v[50:51], v78 offset:6912
    v_mfma_f32_32x32x16_bf16 v[192:207], v[64:67], v[56:59], v[192:207]
    s_waitcnt lgkmcnt(8)
    v_mfma_f32_32x32x16_bf16 v[160:175], v[68:71], v[52:55], v[160:175]
    v_mfma_f32_32x32x16_bf16 v[208:223], v[68:71], v[56:59], v[208:223]
    s_waitcnt lgkmcnt(5)
    v_mfma_f32_32x32x16_bf16 v[128:143], v[40:43], v[32:35], v[128:143]
    ds_read_b128 v[52:55], v75 offset:0
    ds_read_b64_tr_b16 v[60:61], v76 offset:9216
    ds_read_b64_tr_b16 v[62:63], v76 offset:9984
    s_waitcnt lgkmcnt(7)
    v_mfma_f32_32x32x16_bf16 v[176:191], v[40:43], v[36:39], v[176:191]
    ds_read_b128 v[56:59], v75 offset:4096
    ds_read_b64_tr_b16 v[64:65], v77 offset:9216
    ds_read_b64_tr_b16 v[66:67], v77 offset:9984
    s_waitcnt lgkmcnt(8)
    v_mfma_f32_32x32x16_bf16 v[144:159], v[44:47], v[32:35], v[144:159]
    ds_read_b64_tr_b16 v[68:69], v78 offset:9216
    ds_read_b64_tr_b16 v[70:71], v78 offset:9984
    v_mfma_f32_32x32x16_bf16 v[192:207], v[44:47], v[36:39], v[192:207]
    s_waitcnt lgkmcnt(8)
    v_mfma_f32_32x32x16_bf16 v[160:175], v[48:51], v[32:35], v[160:175]
    v_mfma_f32_32x32x16_bf16 v[208:223], v[48:51], v[36:39], v[208:223]
    s_waitcnt lgkmcnt(5)
    v_mfma_f32_32x32x16_bf16 v[128:143], v[60:63], v[52:55], v[128:143]
    s_waitcnt lgkmcnt(4)
    v_mfma_f32_32x32x16_bf16 v[176:191], v[60:63], v[56:59], v[176:191]
    s_waitcnt lgkmcnt(0)
    s_barrier
    ds_read_b128 v[32:35], v72 offset:40960
    ds_read_b64_tr_b16 v[40:41], v76 offset:40960
    ds_read_b64_tr_b16 v[42:43], v76 offset:41728
    v_mfma_f32_32x32x16_bf16 v[144:159], v[64:67], v[52:55], v[144:159]
    ds_read_b128 v[36:39], v72 offset:45056
    ds_read_b64_tr_b16 v[44:45], v77 offset:40960
    ds_read_b64_tr_b16 v[46:47], v77 offset:41728
    v_mfma_f32_32x32x16_bf16 v[192:207], v[64:67], v[56:59], v[192:207]
    ds_read_b64_tr_b16 v[48:49], v78 offset:40960
    ds_read_b64_tr_b16 v[50:51], v78 offset:41728
    v_mfma_f32_32x32x16_bf16 v[160:175], v[68:71], v[52:55], v[160:175]
    v_mfma_f32_32x32x16_bf16 v[208:223], v[68:71], v[56:59], v[208:223]
    s_waitcnt lgkmcnt(5)
    v_mfma_f32_32x32x16_bf16 v[128:143], v[40:43], v[32:35], v[128:143]
    ds_read_b128 v[52:55], v73 offset:40960
    ds_read_b64_tr_b16 v[60:61], v76 offset:44032
    ds_read_b64_tr_b16 v[62:63], v76 offset:44800
    s_waitcnt lgkmcnt(7)
    v_mfma_f32_32x32x16_bf16 v[176:191], v[40:43], v[36:39], v[176:191]
    ds_read_b128 v[56:59], v73 offset:45056
    ds_read_b64_tr_b16 v[64:65], v77 offset:44032
    ds_read_b64_tr_b16 v[66:67], v77 offset:44800
    s_waitcnt lgkmcnt(8)
    v_mfma_f32_32x32x16_bf16 v[144:159], v[44:47], v[32:35], v[144:159]
    ds_read_b64_tr_b16 v[68:69], v78 offset:44032
    ds_read_b64_tr_b16 v[70:71], v78 offset:44800
    v_mfma_f32_32x32x16_bf16 v[192:207], v[44:47], v[36:39], v[192:207]
    s_waitcnt lgkmcnt(8)
    v_mfma_f32_32x32x16_bf16 v[160:175], v[48:51], v[32:35], v[160:175]
    v_mfma_f32_32x32x16_bf16 v[208:223], v[48:51], v[36:39], v[208:223]
    s_waitcnt lgkmcnt(5)
    v_mfma_f32_32x32x16_bf16 v[128:143], v[60:63], v[52:55], v[128:143]
    ds_read_b128 v[32:35], v74 offset:40960
    ds_read_b64_tr_b16 v[40:41], v76 offset:47104
    ds_read_b64_tr_b16 v[42:43], v76 offset:47872
    s_waitcnt lgkmcnt(7)
    v_mfma_f32_32x32x16_bf16 v[176:191], v[60:63], v[56:59], v[176:191]
    ds_read_b128 v[36:39], v74 offset:45056
    ds_read_b64_tr_b16 v[44:45], v77 offset:47104
    ds_read_b64_tr_b16 v[46:47], v77 offset:47872
    s_waitcnt lgkmcnt(8)
    v_mfma_f32_32x32x16_bf16 v[144:159], v[64:67], v[52:55], v[144:159]
    ds_read_b64_tr_b16 v[48:49], v78 offset:47104
    ds_read_b64_tr_b16 v[50:51], v78 offset:47872
    v_mfma_f32_32x32x16_bf16 v[192:207], v[64:67], v[56:59], v[192:207]
    s_waitcnt lgkmcnt(8)
    v_mfma_f32_32x32x16_bf16 v[160:175], v[68:71], v[52:55], v[160:175]
    v_mfma_f32_32x32x16_bf16 v[208:223], v[68:71], v[56:59], v[208:223]
    s_waitcnt lgkmcnt(5)
    v_mfma_f32_32x32x16_bf16 v[128:143], v[40:43], v[32:35], v[128:143]
    ds_read_b128 v[52:55], v75 offset:40960
    ds_read_b64_tr_b16 v[60:61], v76 offset:50176
    ds_read_b64_tr_b16 v[62:63], v76 offset:50944
    s_waitcnt lgkmcnt(7)
    v_mfma_f32_32x32x16_bf16 v[176:191], v[40:43], v[36:39], v[176:191]
    ds_read_b128 v[56:59], v75 offset:45056
    ds_read_b64_tr_b16 v[64:65], v77 offset:50176
    ds_read_b64_tr_b16 v[66:67], v77 offset:50944
    s_waitcnt lgkmcnt(8)
    v_mfma_f32_32x32x16_bf16 v[144:159], v[44:47], v[32:35], v[144:159]
    ds_read_b64_tr_b16 v[68:69], v78 offset:50176
    ds_read_b64_tr_b16 v[70:71], v78 offset:50944
    v_mfma_f32_32x32x16_bf16 v[192:207], v[44:47], v[36:39], v[192:207]
    s_waitcnt lgkmcnt(8)
    v_mfma_f32_32x32x16_bf16 v[160:175], v[48:51], v[32:35], v[160:175]
    v_mfma_f32_32x32x16_bf16 v[208:223], v[48:51], v[36:39], v[208:223]
    s_waitcnt lgkmcnt(5)
    v_mfma_f32_32x32x16_bf16 v[128:143], v[60:63], v[52:55], v[128:143]
    s_waitcnt lgkmcnt(4)
    v_mfma_f32_32x32x16_bf16 v[176:191], v[60:63], v[56:59], v[176:191]
    s_waitcnt lgkmcnt(0)
    s_barrier
    ds_read_b128 v[32:35], v88 offset:0
    ds_read_b64_tr_b16 v[40:41], v92 offset:0
    ds_read_b64_tr_b16 v[42:43], v92 offset:768
    v_mfma_f32_32x32x16_bf16 v[144:159], v[64:67], v[52:55], v[144:159]
    ds_read_b128 v[36:39], v88 offset:4096
    ds_read_b64_tr_b16 v[44:45], v93 offset:0
    ds_read_b64_tr_b16 v[46:47], v93 offset:768
    v_mfma_f32_32x32x16_bf16 v[192:207], v[64:67], v[56:59], v[192:207]
    ds_read_b64_tr_b16 v[48:49], v94 offset:0
    ds_read_b64_tr_b16 v[50:51], v94 offset:768
    v_mfma_f32_32x32x16_bf16 v[160:175], v[68:71], v[52:55], v[160:175]
    v_mfma_f32_32x32x16_bf16 v[208:223], v[68:71], v[56:59], v[208:223]
    s_waitcnt lgkmcnt(5)
    v_mfma_f32_32x32x16_bf16 v[128:143], v[40:43], v[32:35], v[128:143]
    ds_read_b128 v[52:55], v89 offset:0
    ds_read_b64_tr_b16 v[60:61], v92 offset:3072
    ds_read_b64_tr_b16 v[62:63], v92 offset:3840
    s_waitcnt lgkmcnt(7)
    v_mfma_f32_32x32x16_bf16 v[176:191], v[40:43], v[36:39], v[176:191]
    ds_read_b128 v[56:59], v89 offset:4096
    ds_read_b64_tr_b16 v[64:65], v93 offset:3072
    ds_read_b64_tr_b16 v[66:67], v93 offset:3840
    s_waitcnt lgkmcnt(8)
    v_mfma_f32_32x32x16_bf16 v[144:159], v[44:47], v[32:35], v[144:159]
    ds_read_b64_tr_b16 v[68:69], v94 offset:3072
    ds_read_b64_tr_b16 v[70:71], v94 offset:3840
    v_mfma_f32_32x32x16_bf16 v[192:207], v[44:47], v[36:39], v[192:207]
    s_waitcnt lgkmcnt(8)
    v_mfma_f32_32x32x16_bf16 v[160:175], v[48:51], v[32:35], v[160:175]
    v_mfma_f32_32x32x16_bf16 v[208:223], v[48:51], v[36:39], v[208:223]
    s_waitcnt lgkmcnt(5)
    v_mfma_f32_32x32x16_bf16 v[128:143], v[60:63], v[52:55], v[128:143]
    ds_read_b128 v[32:35], v90 offset:0
    ds_read_b64_tr_b16 v[40:41], v92 offset:6144
    ds_read_b64_tr_b16 v[42:43], v92 offset:6912
    s_waitcnt lgkmcnt(7)
    v_mfma_f32_32x32x16_bf16 v[176:191], v[60:63], v[56:59], v[176:191]
    ds_read_b128 v[36:39], v90 offset:4096
    ds_read_b64_tr_b16 v[44:45], v93 offset:6144
    ds_read_b64_tr_b16 v[46:47], v93 offset:6912
    s_waitcnt lgkmcnt(8)
    v_mfma_f32_32x32x16_bf16 v[144:159], v[64:67], v[52:55], v[144:159]
    ds_read_b64_tr_b16 v[48:49], v94 offset:6144
    ds_read_b64_tr_b16 v[50:51], v94 offset:6912
    v_mfma_f32_32x32x16_bf16 v[192:207], v[64:67], v[56:59], v[192:207]
    s_waitcnt lgkmcnt(8)
    v_mfma_f32_32x32x16_bf16 v[160:175], v[68:71], v[52:55], v[160:175]
    v_mfma_f32_32x32x16_bf16 v[208:223], v[68:71], v[56:59], v[208:223]
    s_waitcnt lgkmcnt(5)
    v_mfma_f32_32x32x16_bf16 v[128:143], v[40:43], v[32:35], v[128:143]
    ds_read_b128 v[52:55], v91 offset:0
    ds_read_b64_tr_b16 v[60:61], v92 offset:9216
    ds_read_b64_tr_b16 v[62:63], v92 offset:9984
    s_waitcnt lgkmcnt(7)
    v_mfma_f32_32x32x16_bf16 v[176:191], v[40:43], v[36:39], v[176:191]
    ds_read_b128 v[56:59], v91 offset:4096
    ds_read_b64_tr_b16 v[64:65], v93 offset:9216
    ds_read_b64_tr_b16 v[66:67], v93 offset:9984
    s_waitcnt lgkmcnt(8)
    v_mfma_f32_32x32x16_bf16 v[144:159], v[44:47], v[32:35], v[144:159]
    ds_read_b64_tr_b16 v[68:69], v94 offset:9216
    ds_read_b64_tr_b16 v[70:71], v94 offset:9984
    v_mfma_f32_32x32x16_bf16 v[192:207], v[44:47], v[36:39], v[192:207]
    s_waitcnt lgkmcnt(8)
    v_mfma_f32_32x32x16_bf16 v[160:175], v[48:51], v[32:35], v[160:175]
    v_mfma_f32_32x32x16_bf16 v[208:223], v[48:51], v[36:39], v[208:223]
    s_waitcnt lgkmcnt(5)
    v_mfma_f32_32x32x16_bf16 v[128:143], v[60:63], v[52:55], v[128:143]
    s_waitcnt lgkmcnt(4)
    v_mfma_f32_32x32x16_bf16 v[176:191], v[60:63], v[56:59], v[176:191]
    s_waitcnt lgkmcnt(0)
    s_barrier
    ds_read_b128 v[32:35], v88 offset:40960
    ds_read_b64_tr_b16 v[40:41], v92 offset:40960
    ds_read_b64_tr_b16 v[42:43], v92 offset:41728
    v_mfma_f32_32x32x16_bf16 v[144:159], v[64:67], v[52:55], v[144:159]
    ds_read_b128 v[36:39], v88 offset:45056
    ds_read_b64_tr_b16 v[44:45], v93 offset:40960
    ds_read_b64_tr_b16 v[46:47], v93 offset:41728
    v_mfma_f32_32x32x16_bf16 v[192:207], v[64:67], v[56:59], v[192:207]
    ds_read_b64_tr_b16 v[48:49], v94 offset:40960
    ds_read_b64_tr_b16 v[50:51], v94 offset:41728
    v_mfma_f32_32x32x16_bf16 v[160:175], v[68:71], v[52:55], v[160:175]
    v_mfma_f32_32x32x16_bf16 v[208:223], v[68:71], v[56:59], v[208:223]
    s_waitcnt lgkmcnt(5)
    v_mfma_f32_32x32x16_bf16 v[128:143], v[40:43], v[32:35], v[128:143]
    ds_read_b128 v[52:55], v89 offset:40960
    ds_read_b64_tr_b16 v[60:61], v92 offset:44032
    ds_read_b64_tr_b16 v[62:63], v92 offset:44800
    s_waitcnt lgkmcnt(7)
    v_mfma_f32_32x32x16_bf16 v[176:191], v[40:43], v[36:39], v[176:191]
    ds_read_b128 v[56:59], v89 offset:45056
    ds_read_b64_tr_b16 v[64:65], v93 offset:44032
    ds_read_b64_tr_b16 v[66:67], v93 offset:44800
    s_waitcnt lgkmcnt(8)
    v_mfma_f32_32x32x16_bf16 v[144:159], v[44:47], v[32:35], v[144:159]
    ds_read_b64_tr_b16 v[68:69], v94 offset:44032
    ds_read_b64_tr_b16 v[70:71], v94 offset:44800
    v_mfma_f32_32x32x16_bf16 v[192:207], v[44:47], v[36:39], v[192:207]
    s_waitcnt lgkmcnt(8)
    v_mfma_f32_32x32x16_bf16 v[160:175], v[48:51], v[32:35], v[160:175]
    v_mfma_f32_32x32x16_bf16 v[208:223], v[48:51], v[36:39], v[208:223]
    s_waitcnt lgkmcnt(5)
    v_mfma_f32_32x32x16_bf16 v[128:143], v[60:63], v[52:55], v[128:143]
    ds_read_b128 v[32:35], v90 offset:40960
    ds_read_b64_tr_b16 v[40:41], v92 offset:47104
    ds_read_b64_tr_b16 v[42:43], v92 offset:47872
    s_waitcnt lgkmcnt(7)
    v_mfma_f32_32x32x16_bf16 v[176:191], v[60:63], v[56:59], v[176:191]
    ds_read_b128 v[36:39], v90 offset:45056
    ds_read_b64_tr_b16 v[44:45], v93 offset:47104
    ds_read_b64_tr_b16 v[46:47], v93 offset:47872
    s_waitcnt lgkmcnt(8)
    v_mfma_f32_32x32x16_bf16 v[144:159], v[64:67], v[52:55], v[144:159]
    ds_read_b64_tr_b16 v[48:49], v94 offset:47104
    ds_read_b64_tr_b16 v[50:51], v94 offset:47872
    v_mfma_f32_32x32x16_bf16 v[192:207], v[64:67], v[56:59], v[192:207]
    s_waitcnt lgkmcnt(8)
    v_mfma_f32_32x32x16_bf16 v[160:175], v[68:71], v[52:55], v[160:175]
    v_mfma_f32_32x32x16_bf16 v[208:223], v[68:71], v[56:59], v[208:223]
    s_waitcnt lgkmcnt(5)
    v_mfma_f32_32x32x16_bf16 v[128:143], v[40:43], v[32:35], v[128:143]
    ds_read_b128 v[52:55], v91 offset:40960
    ds_read_b64_tr_b16 v[60:61], v92 offset:50176
    ds_read_b64_tr_b16 v[62:63], v92 offset:50944
    s_waitcnt lgkmcnt(7)
    v_mfma_f32_32x32x16_bf16 v[176:191], v[40:43], v[36:39], v[176:191]
    ds_read_b128 v[56:59], v91 offset:45056
    ds_read_b64_tr_b16 v[64:65], v93 offset:50176
    ds_read_b64_tr_b16 v[66:67], v93 offset:50944
    s_waitcnt lgkmcnt(8)
    v_mfma_f32_32x32x16_bf16 v[144:159], v[44:47], v[32:35], v[144:159]
    ds_read_b64_tr_b16 v[68:69], v94 offset:50176
    ds_read_b64_tr_b16 v[70:71], v94 offset:50944
    v_mfma_f32_32x32x16_bf16 v[192:207], v[44:47], v[36:39], v[192:207]
    s_waitcnt lgkmcnt(8)
    v_mfma_f32_32x32x16_bf16 v[160:175], v[48:51], v[32:35], v[160:175]
    v_mfma_f32_32x32x16_bf16 v[208:223], v[48:51], v[36:39], v[208:223]
    s_waitcnt lgkmcnt(5)
    v_mfma_f32_32x32x16_bf16 v[128:143], v[60:63], v[52:55], v[128:143]
    s_waitcnt lgkmcnt(4)
    v_mfma_f32_32x32x16_bf16 v[176:191], v[60:63], v[56:59], v[176:191]
    s_waitcnt lgkmcnt(0)
    s_barrier
    ds_read_b128 v[32:35], v72 offset:0
    ds_read_b64_tr_b16 v[40:41], v76 offset:0
    ds_read_b64_tr_b16 v[42:43], v76 offset:768
    v_mfma_f32_32x32x16_bf16 v[144:159], v[64:67], v[52:55], v[144:159]
    ds_read_b128 v[36:39], v72 offset:4096
    ds_read_b64_tr_b16 v[44:45], v77 offset:0
    ds_read_b64_tr_b16 v[46:47], v77 offset:768
    v_mfma_f32_32x32x16_bf16 v[192:207], v[64:67], v[56:59], v[192:207]
    ds_read_b64_tr_b16 v[48:49], v78 offset:0
    ds_read_b64_tr_b16 v[50:51], v78 offset:768
    v_mfma_f32_32x32x16_bf16 v[160:175], v[68:71], v[52:55], v[160:175]
    v_mfma_f32_32x32x16_bf16 v[208:223], v[68:71], v[56:59], v[208:223]
    s_cmp_lg_u32 s50, 0
    s_cbranch_scc1 C_nn2
    buffer_load_dwordx2 v[246:247], v248, s[44:47], 0 offen sc1
C_nn2:
    s_waitcnt lgkmcnt(5)
    v_mfma_f32_32x32x16_bf16 v[128:143], v[40:43], v[32:35], v[128:143]
    ds_read_b128 v[52:55], v73 offset:0
    ds_read_b64_tr_b16 v[60:61], v76 offset:3072
    ds_read_b64_tr_b16 v[62:63], v76 offset:3840
    s_waitcnt lgkmcnt(7)
    v_mfma_f32_32x32x16_bf16 v[176:191], v[40:43], v[36:39], v[176:191]
    ds_read_b128 v[56:59], v73 offset:4096
    ds_read_b64_tr_b16 v[64:65], v77 offset:3072
    ds_read_b64_tr_b16 v[66:67], v77 offset:3840
    s_waitcnt lgkmcnt(8)
    v_mfma_f32_32x32x16_bf16 v[144:159], v[44:47], v[32:35], v[144:159]
    ds_read_b64_tr_b16 v[68:69], v78 offset:3072
    ds_read_b64_tr_b16 v[70:71], v78 offset:3840
    v_mfma_f32_32x32x16_bf16 v[192:207], v[44:47], v[36:39], v[192:207]
    s_waitcnt lgkmcnt(8)
    v_mfma_f32_32x32x16_bf16 v[160:175], v[48:51], v[32:35], v[160:175]
    v_mfma_f32_32x32x16_bf16 v[208:223], v[48:51], v[36:39], v[208:223]
    s_waitcnt lgkmcnt(5)
    v_mfma_f32_32x32x16_bf16 v[128:143], v[60:63], v[52:55], v[128:143]
    ds_read_b128 v[32:35], v74 offset:0
    ds_read_b64_tr_b16 v[40:41], v76 offset:6144
    ds_read_b64_tr_b16 v[42:43], v76 offset:6912
    s_waitcnt lgkmcnt(7)
    v_mfma_f32_32x32x16_bf16 v[176:191], v[60:63], v[56:59], v[176:191]
    ds_read_b128 v[36:39], v74 offset:4096
    ds_read_b64_tr_b16 v[44:45], v77 offset:6144
    ds_read_b64_tr_b16 v[46:47], v77 offset:6912
    s_waitcnt lgkmcnt(8)
    v_mfma_f32_32x32x16_bf16 v[144:159], v[64:67], v[52:55], v[144:159]
    ds_read_b64_tr_b16 v[48:49], v78 offset:6144
    ds_read_b64_tr_b16 v[50:51], v78 offset:6912
    v_mfma_f32_32x32x16_bf16 v[192:207], v[64:67], v[56:59], v[192:207]
    s_waitcnt lgkmcnt(8)
    v_mfma_f32_32x32x16_bf16 v[160:175], v[68:71], v[52:55], v[160:175]
    v_mfma_f32_32x32x16_bf16 v[208:223], v[68:71], v[56:59], v[208:223]
    s_waitcnt lgkmcnt(5)
    v_mfma_f32_32x32x16_bf16 v[128:143], v[40:43], v[32:35], v[128:143]
    ds_read_b128 v[52:55], v75 offset:0
    ds_read_b64_tr_b16 v[60:61], v76 offset:9216
    ds_read_b64_tr_b16 v[62:63], v76 offset:9984
    s_waitcnt lgkmcnt(7)
    v_mfma_f32_32x32x16_bf16 v[176:191], v[40:43], v[36:39], v[176:191]
    ds_read_b128 v[56:59], v75 offset:4096
    ds_read_b64_tr_b16 v[64:65], v77 offset:9216
    ds_read_b64_tr_b16 v[66:67], v77 offset:9984
    s_waitcnt lgkmcnt(8)
    v_mfma_f32_32x32x16_bf16 v[144:159], v[44:47], v[32:35], v[144:159]
    ds_read_b64_tr_b16 v[68:69], v78 offset:9216
    ds_read_b64_tr_b16 v[70:71], v78 offset:9984
    v_mfma_f32_32x32x16_bf16 v[192:207], v[44:47], v[36:39], v[192:207]
    s_waitcnt lgkmcnt(8)
    v_mfma_f32_32x32x16_bf16 v[160:175], v[48:51], v[32:35], v[160:175]
    v_mfma_f32_32x32x16_bf16 v[208:223], v[48:51], v[36:39], v[208:223]
    s_waitcnt lgkmcnt(5)
    v_mfma_f32_32x32x16_bf16 v[128:143], v[60:63], v[52:55], v[128:143]
    s_waitcnt lgkmcnt(4)
    v_mfma_f32_32x32x16_bf16 v[176:191], v[60:63], v[56:59], v[176:191]
    s_waitcnt lgkmcnt(0)
    s_barrier
    ds_read_b128 v[32:35], v72 offset:40960
    ds_read_b64_tr_b16 v[40:41], v76 offset:40960
    ds_read_b64_tr_b16 v[42:43], v76 offset:41728
    v_mfma_f32_32x32x16_bf16 v[144:159], v[64:67], v[52:55], v[144:159]
    ds_read_b128 v[36:39], v72 offset:45056
    ds_read_b64_tr_b16 v[44:45], v77 offset:40960
    ds_read_b64_tr_b16 v[46:47], v77 offset:41728
    v_mfma_f32_32x32x16_bf16 v[192:207], v[64:67], v[56:59], v[192:207]
    ds_read_b64_tr_b16 v[48:49], v78 offset:40960
    ds_read_b64_tr_b16 v[50:51], v78 offset:41728
    v_mfma_f32_32x32x16_bf16 v[160:175], v[68:71], v[52:55], v[160:175]
    v_mfma_f32_32x32x16_bf16 v[208:223], v[68:71], v[56:59], v[208:223]
    s_waitcnt lgkmcnt(5)
    v_mfma_f32_32x32x16_bf16 v[128:143], v[40:43], v[32:35], v[128:143]
    ds_read_b128 v[52:55], v73 offset:40960
    ds_read_b64_tr_b16 v[60:61], v76 offset:44032
    ds_read_b64_tr_b16 v[62:63], v76 offset:44800
    s_waitcnt lgkmcnt(7)
    v_mfma_f32_32x32x16_bf16 v[176:191], v[40:43], v[36:39], v[176:191]
    ds_read_b128 v[56:59], v73 offset:45056
    ds_read_b64_tr_b16 v[64:65], v77 offset:44032
    ds_read_b64_tr_b16 v[66:67], v77 offset:44800
    s_waitcnt lgkmcnt(8)
    v_mfma_f32_32x32x16_bf16 v[144:159], v[44:47], v[32:35], v[144:159]
    ds_read_b64_tr_b16 v[68:69], v78 offset:44032
    ds_read_b64_tr_b16 v[70:71], v78 offset:44800
    v_mfma_f32_32x32x16_bf16 v[192:207], v[44:47], v[36:39], v[192:207]
    s_waitcnt lgkmcnt(8)
    v_mfma_f32_32x32x16_bf16 v[160:175], v[48:51], v[32:35], v[160:175]
    v_mfma_f32_32x32x16_bf16 v[208:223], v[48:51], v[36:39], v[208:223]
    s_waitcnt lgkmcnt(5)
    v_mfma_f32_32x32x16_bf16 v[128:143], v[60:63], v[52:55], v[128:143]
    ds_read_b128 v[32:35], v74 offset:40960
    ds_read_b64_tr_b16 v[40:41], v76 offset:47104
    ds_read_b64_tr_b16 v[42:43], v76 offset:47872
    s_waitcnt lgkmcnt(7)
    v_mfma_f32_32x32x16_bf16 v[176:191], v[60:63], v[56:59], v[176:191]
    ds_read_b128 v[36:39], v74 offset:45056
    ds_read_b64_tr_b16 v[44:45], v77 offset:47104
    ds_read_b64_tr_b16 v[46:47], v77 offset:47872
    s_waitcnt lgkmcnt(8)
    v_mfma_f32_32x32x16_bf16 v[144:159], v[64:67], v[52:55], v[144:159]
    ds_read_b64_tr_b16 v[48:49], v78 offset:47104
    ds_read_b64_tr_b16 v[50:51], v78 offset:47872
    v_mfma_f32_32x32x16_bf16 v[192:207], v[64:67], v[56:59], v[192:207]
    s_waitcnt lgkmcnt(8)
    v_mfma_f32_32x32x16_bf16 v[160:175], v[68:71], v[52:55], v[160:175]
    v_mfma_f32_32x32x16_bf16 v[208:223], v[68:71], v[56:59], v[208:223]
    s_waitcnt lgkmcnt(5)
    v_mfma_f32_32x32x16_bf16 v[128:143], v[40:43], v[32:35], v[128:143]
    ds_read_b128 v[52:55], v75 offset:40960
    ds_read_b64_tr_b16 v[60:61], v76 offset:50176
    ds_read_b64_tr_b16 v[62:63], v76 offset:50944
    s_waitcnt lgkmcnt(7)
    v_mfma_f32_32x32x16_bf16 v[176:191], v[40:43], v[36:39], v[176:191]
    ds_read_b128 v[56:59], v75 offset:45056
    ds_read_b64_tr_b16 v[64:65], v77 offset:50176
    ds_read_b64_tr_b16 v[66:67], v77 offset:50944
    s_waitcnt lgkmcnt(8)
    v_mfma_f32_32x32x16_bf16 v[144:159], v[44:47], v[32:35], v[144:159]
    ds_read_b64_tr_b16 v[68:69], v78 offset:50176
    ds_read_b64_tr_b16 v[70:71], v78 offset:50944
    v_mfma_f32_32x32x16_bf16 v[192:207], v[44:47], v[36:39], v[192:207]
    s_waitcnt lgkmcnt(8)
    v_mfma_f32_32x32x16_bf16 v[160:175], v[48:51], v[32:35], v[160:175]
    v_mfma_f32_32x32x16_bf16 v[208:223], v[48:51], v[36:39], v[208:223]
    s_waitcnt lgkmcnt(5)
    v_mfma_f32_32x32x16_bf16 v[128:143], v[60:63], v[52:55], v[128:143]
    s_waitcnt lgkmcnt(4)
    v_mfma_f32_32x32x16_bf16 v[176:191], v[60:63], v[56:59], v[176:191]
    s_waitcnt lgkmcnt(0)
    s_barrier
    ds_read_b128 v[32:35], v88 offset:0
    ds_read_b64_tr_b16 v[40:41], v92 offset:0
    ds_read_b64_tr_b16 v[42:43], v92 offset:768
    v_mfma_f32_32x32x16_bf16 v[144:159], v[64:67], v[52:55], v[144:159]
    ds_read_b128 v[36:39], v88 offset:4096
    ds_read_b64_tr_b16 v[44:45], v93 offset:0
    ds_read_b64_tr_b16 v[46:47], v93 offset:768
    v_mfma_f32_32x32x16_bf16 v[192:207], v[64:67], v[56:59], v[192:207]
    ds_read_b64_tr_b16 v[48:49], v94 offset:0
    ds_read_b64_tr_b16 v[50:51], v94 offset:768
    v_mfma_f32_32x32x16_bf16 v[160:175], v[68:71], v[52:55], v[160:175]
    v_mfma_f32_32x32x16_bf16 v[208:223], v[68:71], v[56:59], v[208:223]
    s_waitcnt lgkmcnt(5)
    v_mfma_f32_32x32x16_bf16 v[128:143], v[40:43], v[32:35], v[128:143]
    ds_read_b128 v[52:55], v89 offset:0
    ds_read_b64_tr_b16 v[60:61], v92 offset:3072
    ds_read_b64_tr_b16 v[62:63], v92 offset:3840
    s_waitcnt lgkmcnt(7)
    v_mfma_f32_32x32x16_bf16 v[176:191], v[40:43], v[36:39], v[176:191]
    ds_read_b128 v[56:59], v89 offset:4096
    ds_read_b64_tr_b16 v[64:65], v93 offset:3072
    ds_read_b64_tr_b16 v[66:67], v93 offset:3840
    s_waitcnt lgkmcnt(8)
    v_mfma_f32_32x32x16_bf16 v[144:159], v[44:47], v[32:35], v[144:159]
    ds_read_b64_tr_b16 v[68:69], v94 offset:3072
    ds_read_b64_tr_b16 v[70:71], v94 offset:3840
    v_mfma_f32_32x32x16_bf16 v[192:207], v[44:47], v[36:39], v[192:207]
    s_waitcnt lgkmcnt(8)
    v_mfma_f32_32x32x16_bf16 v[160:175], v[48:51], v[32:35], v[160:175]
    v_mfma_f32_32x32x16_bf16 v[208:223], v[48:51], v[36:39], v[208:223]
    s_waitcnt lgkmcnt(5)
    v_mfma_f32_32x32x16_bf16 v[128:143], v[60:63], v[52:55], v[128:143]
    ds_read_b128 v[32:35], v90 offset:0
    ds_read_b64_tr_b16 v[40:41], v92 offset:6144
    ds_read_b64_tr_b16 v[42:43], v92 offset:6912
    s_waitcnt lgkmcnt(7)
    v_mfma_f32_32x32x16_bf16 v[176:191], v[60:63], v[56:59], v[176:191]
    ds_read_b128 v[36:39], v90 offset:4096
    ds_read_b64_tr_b16 v[44:45], v93 offset:6144
    ds_read_b64_tr_b16 v[46:47], v93 offset:6912
    s_waitcnt lgkmcnt(8)
    v_mfma_f32_32x32x16_bf16 v[144:159], v[64:67], v[52:55], v[144:159]
    ds_read_b64_tr_b16 v[48:49], v94 offset:6144
    ds_read_b64_tr_b16 v[50:51], v94 offset:6912
    v_mfma_f32_32x32x16_bf16 v[192:207], v[64:67], v[56:59], v[192:207]
    s_waitcnt lgkmcnt(8)
    v_mfma_f32_32x32x16_bf16 v[160:175], v[68:71], v[52:55], v[160:175]
    v_mfma_f32_32x32x16_bf16 v[208:223], v[68:71], v[56:59], v[208:223]
    s_waitcnt lgkmcnt(5)
    v_mfma_f32_32x32x16_bf16 v[128:143], v[40:43], v[32:35], v[128:143]
    ds_read_b128 v[52:55], v91 offset:0
    ds_read_b64_tr_b16 v[60:61], v92 offset:9216
    ds_read_b64_tr_b16 v[62:63], v92 offset:9984
    s_waitcnt lgkmcnt(7)
    v_mfma_f32_32x32x16_bf16 v[176:191], v[40:43], v[36:39], v[176:191]
    ds_read_b128 v[56:59], v91 offset:4096
    ds_read_b64_tr_b16 v[64:65], v93 offset:9216
    ds_read_b64_tr_b16 v[66:67], v93 offset:9984
    s_waitcnt lgkmcnt(8)
    v_mfma_f32_32x32x16_bf16 v[144:159], v[44:47], v[32:35], v[144:159]
    ds_read_b64_tr_b16 v[68:69], v94 offset:9216
    ds_read_b64_tr_b16 v[70:71], v94 offset:9984
    v_mfma_f32_32x32x16_bf16 v[192:207], v[44:47], v[36:39], v[192:207]
    s_waitcnt lgkmcnt(8)
    v_mfma_f32_32x32x16_bf16 v[160:175], v[48:51], v[32:35], v[160:175]
    v_mfma_f32_32x32x16_bf16 v[208:223], v[48:51], v[36:39], v[208:223]
    s_waitcnt lgkmcnt(5)
    v_mfma_f32_32x32x16_bf16 v[128:143], v[60:63], v[52:55], v[128:143]
    s_waitcnt lgkmcnt(4)
    v_mfma_f32_32x32x16_bf16 v[176:191], v[60:63], v[56:59], v[176:191]
    s_waitcnt lgkmcnt(0)
    s_barrier
    ds_read_b128 v[32:35], v88 offset:40960
    ds_read_b64_tr_b16 v[40:41], v92 offset:40960
    ds_read_b64_tr_b16 v[42:43], v92 offset:41728
    v_mfma_f32_32x32x16_bf16 v[144:159], v[64:67], v[52:55], v[144:159]
    ds_read_b128 v[36:39], v88 offset:45056
    ds_read_b64_tr_b16 v[44:45], v93 offset:40960
    ds_read_b64_tr_b16 v[46:47], v93 offset:41728
    v_mfma_f32_32x32x16_bf16 v[192:207], v[64:67], v[56:59], v[192:207]
    ds_read_b64_tr_b16 v[48:49], v94 offset:40960
    ds_read_b64_tr_b16 v[50:51], v94 offset:41728
    v_mfma_f32_32x32x16_bf16 v[160:175], v[68:71], v[52:55], v[160:175]
    v_mfma_f32_32x32x16_bf16 v[208:223], v[68:71], v[56:59], v[208:223]
    ds_read_b128 v[100:103], v90 offset:40960
    ds_read_b64_tr_b16 v[108:109], v92 offset:47104
    ds_read_b64_tr_b16 v[110:111], v92 offset:47872
    ds_read_b128 v[224:227], v91 offset:40960
    ds_read_b64_tr_b16 v[232:233], v92 offset:50176
    ds_read_b64_tr_b16 v[234:235], v92 offset:50944
    s_waitcnt vmcnt(0)
    s_waitcnt lgkmcnt(11)
    v_mfma_f32_32x32x16_bf16 v[128:143], v[40:43], v[32:35], v[128:143]
    ds_read_b128 v[52:55], v89 offset:40960
    ds_read_b64_tr_b16 v[60:61], v92 offset:44032
    ds_read_b64_tr_b16 v[62:63], v92 offset:44800
    s_waitcnt lgkmcnt(6)
    v_mfma_f32_32x32x16_bf16 v[128:143], v[108:111], v[100:103], v[128:143]
    ds_read_b128 v[56:59], v89 offset:45056
    ds_read_b128 v[104:107], v90 offset:45056
    ds_read_b128 v[228:231], v91 offset:45056
    s_waitcnt lgkmcnt(6)
    v_mfma_f32_32x32x16_bf16 v[128:143], v[232:235], v[224:227], v[128:143]
    ds_read_b64_tr_b16 v[64:65], v93 offset:44032
    ds_read_b64_tr_b16 v[66:67], v93 offset:44800
    ds_read_b64_tr_b16 v[112:113], v93 offset:47104
    s_waitcnt lgkmcnt(6)
    v_mfma_f32_32x32x16_bf16 v[128:143], v[60:63], v[52:55], v[128:143]
    ds_read_b64_tr_b16 v[114:115], v93 offset:47872
    ds_read_b64_tr_b16 v[236:237], v93 offset:50176
    ds_read_b64_tr_b16 v[238:239], v93 offset:50944
    v_mfma_f32_32x32x16_bf16 v[176:191], v[40:43], v[36:39], v[176:191]
    ds_read_b64_tr_b16 v[68:69], v94 offset:44032
    ds_read_b64_tr_b16 v[70:71], v94 offset:44800
    ds_read_b64_tr_b16 v[116:117], v94 offset:47104
    s_waitcnt lgkmcnt(11)
    v_mfma_f32_32x32x16_bf16 v[176:191], v[60:63], v[56:59], v[176:191]
    ds_read_b64_tr_b16 v[118:119], v94 offset:47872
    ds_read_b64_tr_b16 v[240:241], v94 offset:50176
    ds_read_b64_tr_b16 v[242:243], v94 offset:50944
    s_waitcnt lgkmcnt(13)
    v_mfma_f32_32x32x16_bf16 v[176:191], v[108:111], v[104:107], v[176:191]
    s_waitcnt lgkmcnt(12)
    v_mfma_f32_32x32x16_bf16 v[176:191], v[232:235], v[228:231], v[176:191]
    s_waitcnt lgkmcnt(0)
    s_barrier
    v_mfma_f32_32x32x16_bf16 v[144:159], v[44:47], v[32:35], v[144:159]
    v_mul_f32 v8, s61, v128
    v_mul_f32 v9, s61, v129
    v_mul_f32 v10, s61, v130
    v_mul_f32 v11, s61, v131
    v_mul_f32 v12, s61, v132
    v_mul_f32 v13, s61, v133
    v_mul_f32 v14, s61, v134
    v_mul_f32 v15, s61, v135
    v_exp_f32 v8, v8
    v_exp_f32 v9, v9
    v_exp_f32 v10, v10
    v_exp_f32 v11, v11
    v_exp_f32 v12, v12
    v_mfma_f32_32x32x16_bf16 v[144:159], v[64:67], v[52:55], v[144:159]
    v_exp_f32 v13, v13
    v_exp_f32 v14, v14
    v_exp_f32 v15, v15
    v_mul_f32 v128, v128, v136
    v_mul_f32 v129, v129, v137
    v_mul_f32 v130, v130, v138
    v_mul_f32 v131, v131, v139
    v_mul_f32 v132, v132, v140
    v_mul_f32 v133, v133, v141
    v_mul_f32 v134, v134, v142
    v_mul_f32 v135, v135, v143
    v_add_f32 v8, 1.0, v8
    v_add_f32 v9, 1.0, v9
    v_mfma_f32_32x32x16_bf16 v[144:159], v[112:115], v[100:103], v[144:159]
    v_add_f32 v10, 1.0, v10
    v_add_f32 v11, 1.0, v11
    v_add_f32 v12, 1.0, v12
    v_add_f32 v13, 1.0, v13
    v_add_f32 v14, 1.0, v14
    v_add_f32 v15, 1.0, v15
    v_rcp_f32 v8, v8
    v_rcp_f32 v9, v9
    v_rcp_f32 v10, v10
    v_rcp_f32 v11, v11
    v_rcp_f32 v12, v12
    v_rcp_f32 v13, v13
    v_rcp_f32 v14, v14
    v_mfma_f32_32x32x16_bf16 v[144:159], v[236:239], v[224:227], v[144:159]
    v_rcp_f32 v15, v15
    s_nop 0
    v_mul_f32 v8, v8, v128
    v_mul_f32 v9, v9, v129
    v_mul_f32 v10, v10, v130
    v_mul_f32 v11, v11, v131
    v_mul_f32 v12, v12, v132
    v_mul_f32 v13, v13, v133
    v_mul_f32 v14, v14, v134
    v_mul_f32 v15, v15, v135
    v_cvt_pk_bf16_f32 v16, v8, v9
    v_cvt_pk_bf16_f32 v17, v10, v11
    v_cvt_pk_bf16_f32 v18, v12, v13
    v_cvt_pk_bf16_f32 v19, v14, v15
    buffer_store_dwordx4 v[16:19], v3, s[40:43], s53 offen sc1
    v_mfma_f32_32x32x16_bf16 v[192:207], v[44:47], v[36:39], v[192:207]
    v_mul_f32 v20, s61, v176
    v_mul_f32 v21, s61, v177
    v_mul_f32 v22, s61, v178
    v_mul_f32 v23, s61, v179
    v_mul_f32 v24, s61, v180
    v_mul_f32 v25, s61, v181
    v_mul_f32 v26, s61, v182
    v_mul_f32 v27, s61, v183
    v_exp_f32 v20, v20
    v_exp_f32 v21, v21
    v_exp_f32 v22, v22
    v_exp_f32 v23, v23
    v_exp_f32 v24, v24
    v_mfma_f32_32x32x16_bf16 v[192:207], v[64:67], v[56:59], v[192:207]
    v_exp_f32 v25, v25
    v_exp_f32 v26, v26
    v_exp_f32 v27, v27
    v_mul_f32 v176, v176, v184
    v_mul_f32 v177, v177, v185
    v_mul_f32 v178, v178, v186
    v_mul_f32 v179, v179, v187
    v_mul_f32 v180, v180, v188
    v_mul_f32 v181, v181, v189
    v_mul_f32 v182, v182, v190
    v_mul_f32 v183, v183, v191
    v_add_f32 v20, 1.0, v20
    v_add_f32 v21, 1.0, v21
    v_mfma_f32_32x32x16_bf16 v[192:207], v[112:115], v[104:107], v[192:207]
    v_add_f32 v22, 1.0, v22
    v_add_f32 v23, 1.0, v23
    v_add_f32 v24, 1.0, v24
    v_add_f32 v25, 1.0, v25
    v_add_f32 v26, 1.0, v26
    v_add_f32 v27, 1.0, v27
    v_rcp_f32 v20, v20
    v_rcp_f32 v21, v21
    v_rcp_f32 v22, v22
    v_rcp_f32 v23, v23
    v_rcp_f32 v24, v24
    v_rcp_f32 v25, v25
    v_rcp_f32 v26, v26
    v_mfma_f32_32x32x16_bf16 v[192:207], v[236:239], v[228:231], v[192:207]
    v_rcp_f32 v27, v27
    s_nop 0
    v_mul_f32 v20, v20, v176
    v_mul_f32 v21, v21, v177
    v_mul_f32 v22, v22, v178
    v_mul_f32 v23, v23, v179
    v_mul_f32 v24, v24, v180
    v_mul_f32 v25, v25, v181
    v_mul_f32 v26, v26, v182
    v_mul_f32 v27, v27, v183
    v_cvt_pk_bf16_f32 v28, v20, v21
    v_cvt_pk_bf16_f32 v29, v22, v23
    v_cvt_pk_bf16_f32 v30, v24, v25
    v_cvt_pk_bf16_f32 v31, v26, v27
    buffer_store_dwordx4 v[28:31], v4, s[40:43], s53 offen sc1
    v_mfma_f32_32x32x16_bf16 v[160:175], v[48:51], v[32:35], v[160:175]
    v_mul_f32 v8, s61, v144
    v_mul_f32 v9, s61, v145
    v_mul_f32 v10, s61, v146
    v_mul_f32 v11, s61, v147
    v_mul_f32 v12, s61, v148
    v_mul_f32 v13, s61, v149
    v_mul_f32 v14, s61, v150
    v_mul_f32 v15, s61, v151
    v_exp_f32 v8, v8
    v_exp_f32 v9, v9
    v_exp_f32 v10, v10
    v_exp_f32 v11, v11
    v_exp_f32 v12, v12
    v_mfma_f32_32x32x16_bf16 v[160:175], v[68:71], v[52:55], v[160:175]
    v_exp_f32 v13, v13
    v_exp_f32 v14, v14
    v_exp_f32 v15, v15
    v_mul_f32 v144, v144, v152
    v_mul_f32 v145, v145, v153
    v_mul_f32 v146, v146, v154
    v_mul_f32 v147, v147, v155
    v_mul_f32 v148, v148, v156
    v_mul_f32 v149, v149, v157
    v_mul_f32 v150, v150, v158
    v_mul_f32 v151, v151, v159
    v_add_f32 v8, 1.0, v8
    v_add_f32 v9, 1.0, v9
    v_mfma_f32_32x32x16_bf16 v[160:175], v[116:119], v[100:103], v[160:175]
    v_add_f32 v10, 1.0, v10
    v_add_f32 v11, 1.0, v11
    v_add_f32 v12, 1.0, v12
    v_add_f32 v13, 1.0, v13
    v_add_f32 v14, 1.0, v14
    v_add_f32 v15, 1.0, v15
    v_rcp_f32 v8, v8
    v_rcp_f32 v9, v9
    v_rcp_f32 v10, v10
    v_rcp_f32 v11, v11
    v_rcp_f32 v12, v12
    v_rcp_f32 v13, v13
    v_rcp_f32 v14, v14
    v_mfma_f32_32x32x16_bf16 v[160:175], v[240:243], v[224:227], v[160:175]
    v_rcp_f32 v15, v15
    s_nop 0
    v_mul_f32 v8, v8, v144
    v_mul_f32 v9, v9, v145
    v_mul_f32 v10, v10, v146
    v_mul_f32 v11, v11, v147
    v_mul_f32 v12, v12, v148
    v_mul_f32 v13, v13, v149
    v_mul_f32 v14, v14, v150
    v_mul_f32 v15, v15, v151
    v_cvt_pk_bf16_f32 v16, v8, v9
    v_cvt_pk_bf16_f32 v17, v10, v11
    v_cvt_pk_bf16_f32 v18, v12, v13
    v_cvt_pk_bf16_f32 v19, v14, v15
    buffer_store_dwordx4 v[16:19], v3, s[40:43], s54 offen sc1
    v_mfma_f32_32x32x16_bf16 v[208:223], v[48:51], v[36:39], v[208:223]
    v_mul_f32 v20, s61, v192
    v_mul_f32 v21, s61, v193
    v_mul_f32 v22, s61, v194
    v_mul_f32 v23, s61, v195
    v_mul_f32 v24, s61, v196
    v_mul_f32 v25, s61, v197
    v_mul_f32 v26, s61, v198
    v_mul_f32 v27, s61, v199
    v_exp_f32 v20, v20
    v_exp_f32 v21, v21
    v_exp_f32 v22, v22
    v_exp_f32 v23, v23
    v_exp_f32 v24, v24
    v_mfma_f32_32x32x16_bf16 v[208:223], v[68:71], v[56:59], v[208:223]
    v_exp_f32 v25, v25
    v_exp_f32 v26, v26
    v_exp_f32 v27, v27
    v_mul_f32 v192, v192, v200
    v_mul_f32 v193, v193, v201
    v_mul_f32 v194, v194, v202
    v_mul_f32 v195, v195, v203
    v_mul_f32 v196, v196, v204
    v_mul_f32 v197, v197, v205
    v_mul_f32 v198, v198, v206
    v_mul_f32 v199, v199, v207
    v_add_f32 v20, 1.0, v20
    v_add_f32 v21, 1.0, v21
    v_mfma_f32_32x32x16_bf16 v[208:223], v[116:119], v[104:107], v[208:223]
    v_add_f32 v22, 1.0, v22
    v_add_f32 v23, 1.0, v23
    v_add_f32 v24, 1.0, v24
    v_add_f32 v25, 1.0, v25
    v_add_f32 v26, 1.0, v26
    v_add_f32 v27, 1.0, v27
    v_rcp_f32 v20, v20
    v_rcp_f32 v21, v21
    v_rcp_f32 v22, v22
    v_rcp_f32 v23, v23
    v_rcp_f32 v24, v24
    v_rcp_f32 v25, v25
    v_rcp_f32 v26, v26
    v_mfma_f32_32x32x16_bf16 v[208:223], v[240:243], v[228:231], v[208:223]
    v_rcp_f32 v27, v27
    s_nop 0
    v_mul_f32 v20, v20, v192
    v_mul_f32 v21, v21, v193
    v_mul_f32 v22, v22, v194
    v_mul_f32 v23, v23, v195
    v_mul_f32 v24, v24, v196
    v_mul_f32 v25, v25, v197
    v_mul_f32 v26, v26, v198
    v_mul_f32 v27, v27, v199
    v_cvt_pk_bf16_f32 v28, v20, v21
    v_cvt_pk_bf16_f32 v29, v22, v23
    v_cvt_pk_bf16_f32 v30, v24, v25
    v_cvt_pk_bf16_f32 v31, v26, v27
    buffer_store_dwordx4 v[28:31], v4, s[40:43], s54 offen sc1
    v_pk_mul_f32 v[8:9], v[160:161], v[244:245]
    v_pk_mul_f32 v[10:11], v[162:163], v[244:245]
    v_pk_mul_f32 v[12:13], v[164:165], v[244:245]
    v_pk_mul_f32 v[14:15], v[166:167], v[244:245]
    v_exp_f32 v8, v8
    v_exp_f32 v9, v9
    v_exp_f32 v10, v10
    v_exp_f32 v11, v11
    v_exp_f32 v12, v12
    v_exp_f32 v13, v13
    v_exp_f32 v14, v14
    v_exp_f32 v15, v15
    v_pk_mul_f32 v[160:161], v[160:161], v[168:169]
    v_pk_mul_f32 v[162:163], v[162:163], v[170:171]
    v_pk_mul_f32 v[164:165], v[164:165], v[172:173]
    v_pk_mul_f32 v[166:167], v[166:167], v[174:175]
    v_pk_add_f32 v[8:9], v[8:9], 1.0 op_sel_hi:[1,0]
    v_pk_add_f32 v[10:11], v[10:11], 1.0 op_sel_hi:[1,0]
    v_pk_add_f32 v[12:13], v[12:13], 1.0 op_sel_hi:[1,0]
    v_pk_add_f32 v[14:15], v[14:15], 1.0 op_sel_hi:[1,0]
    v_rcp_f32 v8, v8
    v_rcp_f32 v9, v9
    v_rcp_f32 v10, v10
    v_rcp_f32 v11, v11
    v_rcp_f32 v12, v12
    v_rcp_f32 v13, v13
    v_rcp_f32 v14, v14
    v_rcp_f32 v15, v15
    s_nop 0
    v_pk_mul_f32 v[8:9], v[8:9], v[160:161]
    v_pk_mul_f32 v[10:11], v[10:11], v[162:163]
    v_pk_mul_f32 v[12:13], v[12:13], v[164:165]
    v_pk_mul_f32 v[14:15], v[14:15], v[166:167]
    v_cvt_pk_bf16_f32 v16, v8, v9
    v_cvt_pk_bf16_f32 v17, v10, v11
    v_cvt_pk_bf16_f32 v18, v12, v13
    v_cvt_pk_bf16_f32 v19, v14, v15
    buffer_store_dwordx4 v[16:19], v3, s[40:43], s55 offen sc1
    v_pk_mul_f32 v[20:21], v[208:209], v[244:245]
    v_pk_mul_f32 v[22:23], v[210:211], v[244:245]
    v_pk_mul_f32 v[24:25], v[212:213], v[244:245]
    v_pk_mul_f32 v[26:27], v[214:215], v[244:245]
    v_exp_f32 v20, v20
    v_exp_f32 v21, v21
    v_exp_f32 v22, v22
    v_exp_f32 v23, v23
    v_exp_f32 v24, v24
    v_exp_f32 v25, v25
    v_exp_f32 v26, v26
    v_exp_f32 v27, v27
    v_pk_mul_f32 v[208:209], v[208:209], v[216:217]
    v_pk_mul_f32 v[210:211], v[210:211], v[218:219]
    v_pk_mul_f32 v[212:213], v[212:213], v[220:221]
    v_pk_mul_f32 v[214:215], v[214:215], v[222:223]
    v_pk_add_f32 v[20:21], v[20:21], 1.0 op_sel_hi:[1,0]
    v_pk_add_f32 v[22:23], v[22:23], 1.0 op_sel_hi:[1,0]
    v_pk_add_f32 v[24:25], v[24:25], 1.0 op_sel_hi:[1,0]
    v_pk_add_f32 v[26:27], v[26:27], 1.0 op_sel_hi:[1,0]
    v_rcp_f32 v20, v20
    v_rcp_f32 v21, v21
    v_rcp_f32 v22, v22
    v_rcp_f32 v23, v23
    v_rcp_f32 v24, v24
    v_rcp_f32 v25, v25
    v_rcp_f32 v26, v26
    v_rcp_f32 v27, v27
    s_nop 0
    v_pk_mul_f32 v[20:21], v[20:21], v[208:209]
    v_pk_mul_f32 v[22:23], v[22:23], v[210:211]
    v_pk_mul_f32 v[24:25], v[24:25], v[212:213]
    v_pk_mul_f32 v[26:27], v[26:27], v[214:215]
    v_cvt_pk_bf16_f32 v28, v20, v21
    v_cvt_pk_bf16_f32 v29, v22, v23
    v_cvt_pk_bf16_f32 v30, v24, v25
    v_cvt_pk_bf16_f32 v31, v26, v27
    buffer_store_dwordx4 v[28:31], v4, s[40:43], s55 offen sc1
    s_barrier
    s_waitcnt vmcnt(0)
    s_barrier
    s_cmp_lg_u32 s50, 0
    s_cbranch_scc1 C_p2b
    s_mov_b32 s59, 0
C_gna:
    v_readfirstlane_b32 s60, v246
    s_nop 3
    s_cmp_lg_u32 s60, 0
    s_cbranch_scc1 C_gnda
    s_add_u32 s59, s59, 1
    s_cmp_ge_u32 s59, 0x400000
    s_cbranch_scc1 C_gnda
    s_sleep 8
    buffer_load_dwordx2 v[246:247], v248, s[44:47], 0 offen sc1
    s_waitcnt vmcnt(0)
    s_branch C_gna
C_gnda:
    s_lshl_b32 s58, s48, 8
    s_lshl_b32 s59, s49, 3
    s_add_u32 s58, s58, s59
    s_add_u32 s58, s58, 8388608
    v_mov_b32 v3, s58
    s_mov_b64 exec, 1
    buffer_store_dwordx2 v[246:247], v3, s[40:43], 0 offen sc1
    s_mov_b64 exec, -1
    s_branch C_p2b
C_p2:
    s_waitcnt vmcnt(0) lgkmcnt(0)
    s_mov_b32 s40, s16
    s_and_b32 s41, s17, 0xffff
    s_mov_b32 s42, 16777216
    s_mov_b32 s43, 0x00020000
    s_barrier
    s_cmp_lg_u32 s50, 0
    s_cbranch_scc1 C_p2b
    v_mov_b32 v246, 0
    v_mov_b32 v247, 0
    s_mov_b32 s59, 0
C_gnb:
    v_readfirstlane_b32 s60, v246
    s_nop 3
    s_cmp_lg_u32 s60, 0
    s_cbranch_scc1 C_gndb
    s_add_u32 s59, s59, 1
    s_cmp_ge_u32 s59, 0x400000
    s_cbranch_scc1 C_gndb
    s_sleep 8
    buffer_load_dwordx2 v[246:247], v248, s[44:47], 0 offen sc1
    s_waitcnt vmcnt(0)
    s_branch C_gnb
C_gndb:
C_p2b:
    s_mov_b32 s36, s12
    s_and_b32 s37, s13, 0xffff
    s_mov_b32 s38, 2097152
    s_mov_b32 s39, 0x00020000
    s_and_b32 s56, s50, 3
    s_lshr_b32 s57, s50, 2
    s_lshl_b32 s58, s51, 1
    s_add_u32 s59, s58, s57
    s_mul_i32 s59, s59, 86
    s_mul_i32 s61, s56, 22
    s_add_u32 s59, s59, s61
    s_lshl_b32 s59, s59, 10
    v_lshlrev_b32 v3, 4, v1
    v_add_u32 v24, s59, v3
    s_mul_i32 s62, s56, 40960
    s_cmp_eq_u32 s56, 3
    s_cselect_b32 s63, 0, 20480
    s_and_b32 s58, s56, 1
    s_lshr_b32 s59, s56, 1
    v_lshrrev_b32 v3, 5, v1
    v_bfe_u32 v4, v1, 2, 2
    v_lshl_add_u32 v3, v3, 2, v4
    v_lshlrev_b32 v3, 7, v3
    v_bfe_u32 v4, v1, 3, 1
    v_xor_b32 v4, s58, v4
    v_lshl_add_u32 v3, v4, 6, v3
    v_bfe_u32 v4, v1, 4, 1
    v_xor_b32 v4, s59, v4
    v_lshl_add_u32 v3, v4, 5, v3
    v_and_b32 v4, 3, v1
    v_lshl_add_u32 v3, v4, 3, v3
    v_add_u32 v26, s62, v3
    v_xor_b32 v27, 64, v26
    ds_read_b64_tr_b16 v[208:209], v26 offset:0
    ds_read_b64_tr_b16 v[210:211], v26 offset:1024
    ds_read_b64_tr_b16 v[212:213], v27 offset:0
    ds_read_b64_tr_b16 v[214:215], v27 offset:1024
    ds_read_b64_tr_b16 v[216:217], v26 offset:2048
    ds_read_b64_tr_b16 v[218:219], v26 offset:3072
    ds_read_b64_tr_b16 v[220:221], v27 offset:2048
    ds_read_b64_tr_b16 v[222:223], v27 offset:3072
    s_waitcnt lgkmcnt(0)
    s_cmp_lg_u32 s56, 3
    s_cbranch_scc1 P2S_1
    v_mov_b32 v208, 0
    v_mov_b32 v209, 0
    v_mov_b32 v210, 0
    v_mov_b32 v211, 0
    v_mov_b32 v212, 0
    v_mov_b32 v213, 0
    v_mov_b32 v214, 0
    v_mov_b32 v215, 0
    v_mov_b32 v216, 0
    v_mov_b32 v217, 0
    v_mov_b32 v218, 0
    v_mov_b32 v219, 0
    v_mov_b32 v220, 0
    v_mov_b32 v221, 0
    v_mov_b32 v222, 0
    v_mov_b32 v223, 0
P2S_1:
    s_barrier
    s_cmp_lg_u32 s50, 0
    s_cbranch_scc1 P2_main
    s_lshr_b32 s58, s51, 1
    s_lshl_b32 s58, s58, 8
    s_add_u32 s58, s58, 8388608
    v_lshlrev_b32 v3, 3, v1
    v_add_u32 v3, s58, v3
    s_mov_b32 s59, 0
    s_mov_b64 exec, 0x7fff
    buffer_load_dwordx2 v[32:33], v3, s[40:43], 0 offen sc1
    s_sleep 3
C_poll:
    buffer_load_dwordx2 v[34:35], v3, s[40:43], 0 offen sc1
    s_waitcnt vmcnt(1)
    v_cmp_eq_u64 vcc, v[32:33], v[246:247]
    s_add_u32 s59, s59, 1
    s_nop 3
    s_cmp_eq_u64 vcc, exec
    s_cbranch_scc1 C_polled
    s_sleep 3
    buffer_load_dwordx2 v[32:33], v3, s[40:43], 0 offen sc1
    s_waitcnt vmcnt(1)
    v_cmp_eq_u64 vcc, v[34:35], v[246:247]
    s_add_u32 s59, s59, 1
    s_nop 3
    s_cmp_eq_u64 vcc, exec
    s_cbranch_scc1 C_polled
    s_sleep 3
    s_cmp_ge_u32 s59, 0x400000
    s_cbranch_scc0 C_poll
C_polled:
    s_waitcnt vmcnt(0)
    s_mov_b64 exec, -1
    s_branch P2_main
L_loader:
    s_sub_u32 s56, s50, 4
    v_lshrrev_b32 v3, 3, v1
    v_and_b32 v4, 7, v1
    v_lshrrev_b32 v5, 4, v1
    s_lshl_b32 s58, s48, 7
    s_lshl_b32 s59, s56, 5
    s_add_u32 s58, s58, s59
    v_add_u32 v6, s58, v3
    v_lshlrev_b32 v6, 10, v6
    v_add_u32 v7, 0, v5
    v_and_b32 v7, 7, v7
    v_xor_b32 v7, v7, v4
    v_lshl_add_u32 v8, v7, 4, v6
    v_add_u32 v7, 4, v5
    v_and_b32 v7, 7, v7
    v_xor_b32 v7, v7, v4
    v_lshl_add_u32 v9, v7, 4, v6
    v_add_u32 v9, 7168, v9
    v_add_u32 v7, 8, v5
    v_and_b32 v7, 7, v7
    v_xor_b32 v7, v7, v4
    v_lshl_add_u32 v10, v7, 4, v6
    v_add_u32 v10, 14336, v10
    v_add_u32 v7, 12, v5
    v_and_b32 v7, 7, v7
    v_xor_b32 v7, v7, v4
    v_lshl_add_u32 v11, v7, 4, v6
    v_add_u32 v11, 21504, v11
    s_mul_i32 s58, s56, 192
    s_mul_i32 s59, s49, 192
    s_mov_b32 s60, 43691
    s_mov_b32 s61, 2752
    v_add_u32 v6, s58, v1
    v_mul_lo_u32 v7, v6, s60
    v_lshrrev_b32 v7, 19, v7
    v_mul_u32_u24 v19, 12, v7
    v_sub_u32 v19, v6, v19
    v_mul_lo_u32 v7, v7, s61
    v_add_u32 v7, s59, v7
    v_lshl_add_u32 v12, v19, 4, v7
    v_xor_b32 v19, 2, v19
    v_lshl_add_u32 v15, v19, 4, v7
    v_add_u32 v6, s58, v1
    v_add_u32 v6, 64, v6
    v_mul_lo_u32 v7, v6, s60
    v_lshrrev_b32 v7, 19, v7
    v_mul_u32_u24 v19, 12, v7
    v_sub_u32 v19, v6, v19
    v_mul_lo_u32 v7, v7, s61
    v_add_u32 v7, s59, v7
    v_subrev_u32 v7, 1024, v7
    v_lshl_add_u32 v13, v19, 4, v7
    v_xor_b32 v19, 2, v19
    v_lshl_add_u32 v16, v19, 4, v7
    v_add_u32 v6, s58, v1
    v_add_u32 v6, 128, v6
    v_mul_lo_u32 v7, v6, s60
    v_lshrrev_b32 v7, 19, v7
    v_mul_u32_u24 v19, 12, v7
    v_sub_u32 v19, v6, v19
    v_mul_lo_u32 v7, v7, s61
    v_add_u32 v7, s59, v7
    v_subrev_u32 v7, 2048, v7
    v_lshl_add_u32 v14, v19, 4, v7
    v_xor_b32 v19, 2, v19
    v_lshl_add_u32 v17, v19, 4, v7
    s_lshl_b32 s58, s56, 3
    v_add_u32 v6, s58, v3
    v_lshlrev_b32 v6, 10, v6
    s_lshl_b32 s58, s52, 7
    v_add_u32 v6, s58, v6
    v_bfe_u32 v7, v1, 4, 1
    v_lshlrev_b32 v7, 2, v7
    v_xor_b32 v7, v7, v4
    v_lshl_add_u32 v18, v7, 4, v6
    s_lshl_b32 s57, s56, 12
    s_mul_i32 s58, s56, 3072
    s_add_u32 s58, s58, 16384
    s_add_u32 s59, s58, 12288
    s_mov_b32 s55, 0
    s_lshl_b32 s60, s55, 7
    s_mul_i32 s61, s55, 176128
    s_lshl_b32 s18, s56, 10
    s_waitcnt lgkmcnt(0)
    s_mov_b32 s20, s4
    s_and_b32 s21, s5, 0xffff
    s_mov_b32 s22, 2097152
    s_mov_b32 s23, 0x00020000
    s_mov_b32 s24, s6
    s_and_b32 s25, s7, 0xffff
    s_mov_b32 s26, 1409024
    s_mov_b32 s27, 0x00020000
    s_mov_b32 s28, s8
    s_and_b32 s29, s9, 0xffff
    s_mov_b32 s30, 1409024
    s_mov_b32 s31, 0x00020000
    s_mov_b32 s32, s10
    s_and_b32 s33, s11, 0xffff
    s_mov_b32 s34, 1409024
    s_mov_b32 s35, 0x00020000
    s_mov_b32 s40, s16
    s_and_b32 s41, s17, 0xffff
    s_mov_b32 s42, 16777216
    s_mov_b32 s43, 0x00020000
    s_cmp_ge_u32 s49, 15
    s_cbranch_scc1 LD_nop1
    s_add_u32 m0, s57, 0
    s_nop 0
    buffer_load_dwordx4 v8, s[20:23], s60 offen offset:0 lds
    buffer_load_dwordx4 v9, s[20:23], s60 offen offset:1024 lds
    buffer_load_dwordx4 v10, s[20:23], s60 offen offset:2048 lds
    buffer_load_dwordx4 v11, s[20:23], s60 offen offset:3072 lds
    s_add_u32 m0, s58, 0
    s_nop 0
    buffer_load_dwordx4 v12, s[24:27], s61 offen offset:0 lds
    buffer_load_dwordx4 v13, s[24:27], s61 offen offset:1024 lds
    buffer_load_dwordx4 v14, s[24:27], s61 offen offset:2048 lds
    s_add_u32 m0, s59, 0
    s_nop 0
    buffer_load_dwordx4 v15, s[28:31], s61 offen offset:0 lds
    buffer_load_dwordx4 v16, s[28:31], s61 offen offset:1024 lds
    buffer_load_dwordx4 v17, s[28:31], s61 offen offset:2048 lds
    s_add_u32 s55, s55, 1
    s_and_b32 s55, s55, 7
    s_lshl_b32 s60, s55, 7
    s_mul_i32 s61, s55, 176128
    s_add_u32 m0, s57, 40960
    s_nop 0
    buffer_load_dwordx4 v8, s[20:23], s60 offen offset:0 lds
    buffer_load_dwordx4 v9, s[20:23], s60 offen offset:1024 lds
    buffer_load_dwordx4 v10, s[20:23], s60 offen offset:2048 lds
    buffer_load_dwordx4 v11, s[20:23], s60 offen offset:3072 lds
    s_add_u32 m0, s58, 40960
    s_nop 0
    buffer_load_dwordx4 v12, s[24:27], s61 offen offset:0 lds
    buffer_load_dwordx4 v13, s[24:27], s61 offen offset:1024 lds
    buffer_load_dwordx4 v14, s[24:27], s61 offen offset:2048 lds
    s_add_u32 m0, s59, 40960
    s_nop 0
    buffer_load_dwordx4 v15, s[28:31], s61 offen offset:0 lds
    buffer_load_dwordx4 v16, s[28:31], s61 offen offset:1024 lds
    buffer_load_dwordx4 v17, s[28:31], s61 offen offset:2048 lds
    s_add_u32 s55, s55, 1
    s_and_b32 s55, s55, 7
    s_lshl_b32 s60, s55, 7
    s_mul_i32 s61, s55, 176128
    s_waitcnt vmcnt(10)
    s_barrier
    s_add_u32 m0, s57, 81920
    s_nop 0
    buffer_load_dwordx4 v8, s[20:23], s60 offen offset:0 lds
    buffer_load_dwordx4 v9, s[20:23], s60 offen offset:1024 lds
    buffer_load_dwordx4 v10, s[20:23], s60 offen offset:2048 lds
    buffer_load_dwordx4 v11, s[20:23], s60 offen offset:3072 lds
    s_add_u32 m0, s58, 81920
    s_nop 0
    buffer_load_dwordx4 v12, s[24:27], s61 offen offset:0 lds
    buffer_load_dwordx4 v13, s[24:27], s61 offen offset:1024 lds
    buffer_load_dwordx4 v14, s[24:27], s61 offen offset:2048 lds
    s_add_u32 m0, s59, 81920
    s_nop 0
    buffer_load_dwordx4 v15, s[28:31], s61 offen offset:0 lds
    buffer_load_dwordx4 v16, s[28:31], s61 offen offset:1024 lds
    buffer_load_dwordx4 v17, s[28:31], s61 offen offset:2048 lds
    s_add_u32 s55, s55, 1
    s_and_b32 s55, s55, 7
    s_lshl_b32 s60, s55, 7
    s_mul_i32 s61, s55, 176128
    s_add_u32 m0, s57, 122880
    s_nop 0
    buffer_load_dwordx4 v8, s[20:23], s60 offen offset:0 lds
    buffer_load_dwordx4 v9, s[20:23], s60 offen offset:1024 lds
    buffer_load_dwordx4 v10, s[20:23], s60 offen offset:2048 lds
    buffer_load_dwordx4 v11, s[20:23], s60 offen offset:3072 lds
    s_add_u32 m0, s58, 122880
    s_nop 0
    buffer_load_dwordx4 v12, s[24:27], s61 offen offset:0 lds
    buffer_load_dwordx4 v13, s[24:27], s61 offen offset:1024 lds
    buffer_load_dwordx4 v14, s[24:27], s61 offen offset:2048 lds
    s_add_u32 m0, s59, 122880
    s_nop 0
    buffer_load_dwordx4 v15, s[28:31], s61 offen offset:0 lds
    buffer_load_dwordx4 v16, s[28:31], s61 offen offset:1024 lds
    buffer_load_dwordx4 v17, s[28:31], s61 offen offset:2048 lds
    s_add_u32 s55, s55, 1
    s_and_b32 s55, s55, 7
    s_lshl_b32 s60, s55, 7
    s_mul_i32 s61, s55, 176128
    s_waitcnt vmcnt(20)
    s_barrier
    s_add_u32 m0, s57, 0
    s_nop 0
    buffer_load_dwordx4 v8, s[20:23], s60 offen offset:0 lds
    buffer_load_dwordx4 v9, s[20:23], s60 offen offset:1024 lds
    buffer_load_dwordx4 v10, s[20:23], s60 offen offset:2048 lds
    buffer_load_dwordx4 v11, s[20:23], s60 offen offset:3072 lds
    s_add_u32 m0, s58, 0
    s_nop 0
    buffer_load_dwordx4 v12, s[24:27], s61 offen offset:0 lds
    buffer_load_dwordx4 v13, s[24:27], s61 offen offset:1024 lds
    buffer_load_dwordx4 v14, s[24:27], s61 offen offset:2048 lds
    s_add_u32 m0, s59, 0
    s_nop 0
    buffer_load_dwordx4 v15, s[28:31], s61 offen offset:0 lds
    buffer_load_dwordx4 v16, s[28:31], s61 offen offset:1024 lds
    buffer_load_dwordx4 v17, s[28:31], s61 offen offset:2048 lds
    s_add_u32 s55, s55, 1
    s_and_b32 s55, s55, 7
    s_lshl_b32 s60, s55, 7
    s_mul_i32 s61, s55, 176128
    s_waitcnt vmcnt(20)
    s_barrier
    s_add_u32 m0, s57, 40960
    s_nop 0
    buffer_load_dwordx4 v8, s[20:23], s60 offen offset:0 lds
    buffer_load_dwordx4 v9, s[20:23], s60 offen offset:1024 lds
    buffer_load_dwordx4 v10, s[20:23], s60 offen offset:2048 lds
    buffer_load_dwordx4 v11, s[20:23], s60 offen offset:3072 lds
    s_add_u32 m0, s58, 40960
    s_nop 0
    buffer_load_dwordx4 v12, s[24:27], s61 offen offset:0 lds
    buffer_load_dwordx4 v13, s[24:27], s61 offen offset:1024 lds
    buffer_load_dwordx4 v14, s[24:27], s61 offen offset:2048 lds
    s_add_u32 m0, s59, 40960
    s_nop 0
    buffer_load_dwordx4 v15, s[28:31], s61 offen offset:0 lds
    buffer_load_dwordx4 v16, s[28:31], s61 offen offset:1024 lds
    buffer_load_dwordx4 v17, s[28:31], s61 offen offset:2048 lds
    s_add_u32 s55, s55, 1
    s_and_b32 s55, s55, 7
    s_lshl_b32 s60, s55, 7
    s_mul_i32 s61, s55, 176128
    s_lshl_b32 s19, s2, 2
    s_add_u32 s19, s19, s56
    s_mul_i32 s3, s19, 1376
    v_lshlrev_b32 v20, 4, v1
    s_mov_b32 s19, 352
    v_cmp_gt_u32 vcc, s19, v20
    buffer_load_dwordx4 v[28:31], v20, s[32:35], s3 offen
    s_and_saveexec_b64 s[62:63], vcc
    buffer_load_dwordx4 v[32:35], v20, s[32:35], s3 offen offset:1024
    s_mov_b64 exec, s[62:63]
    s_waitcnt vmcnt(22)
    s_barrier
    s_add_u32 m0, s57, 81920
    s_nop 0
    buffer_load_dwordx4 v8, s[20:23], s60 offen offset:0 lds
    buffer_load_dwordx4 v9, s[20:23], s60 offen offset:1024 lds
    buffer_load_dwordx4 v10, s[20:23], s60 offen offset:2048 lds
    buffer_load_dwordx4 v11, s[20:23], s60 offen offset:3072 lds
    s_add_u32 m0, s58, 81920
    s_nop 0
    buffer_load_dwordx4 v12, s[24:27], s61 offen offset:0 lds
    buffer_load_dwordx4 v13, s[24:27], s61 offen offset:1024 lds
    buffer_load_dwordx4 v14, s[24:27], s61 offen offset:2048 lds
    s_add_u32 m0, s59, 81920
    s_nop 0
    buffer_load_dwordx4 v15, s[28:31], s61 offen offset:0 lds
    buffer_load_dwordx4 v16, s[28:31], s61 offen offset:1024 lds
    buffer_load_dwordx4 v17, s[28:31], s61 offen offset:2048 lds
    s_add_u32 s55, s55, 1
    s_and_b32 s55, s55, 7
    s_lshl_b32 s60, s55, 7
    s_mul_i32 s61, s55, 176128
    s_waitcnt vmcnt(22)
    s_barrier
    s_add_u32 m0, s57, 122880
    s_nop 0
    buffer_load_dwordx4 v8, s[20:23], s60 offen offset:0 lds
    buffer_load_dwordx4 v9, s[20:23], s60 offen offset:1024 lds
    buffer_load_dwordx4 v10, s[20:23], s60 offen offset:2048 lds
    buffer_load_dwordx4 v11, s[20:23], s60 offen offset:3072 lds
    s_add_u32 m0, s58, 122880
    s_nop 0
    buffer_load_dwordx4 v12, s[24:27], s61 offen offset:0 lds
    buffer_load_dwordx4 v13, s[24:27], s61 offen offset:1024 lds
    buffer_load_dwordx4 v14, s[24:27], s61 offen offset:2048 lds
    s_add_u32 m0, s59, 122880
    s_nop 0
    buffer_load_dwordx4 v15, s[28:31], s61 offen offset:0 lds
    buffer_load_dwordx4 v16, s[28:31], s61 offen offset:1024 lds
    buffer_load_dwordx4 v17, s[28:31], s61 offen offset:2048 lds
    s_add_u32 s55, s55, 1
    s_and_b32 s55, s55, 7
    s_lshl_b32 s60, s55, 7
    s_mul_i32 s61, s55, 176128
    s_waitcnt vmcnt(22)
    s_barrier
    s_add_u32 m0, s18, 0
    s_mov_b32 s19, 327680
    buffer_load_dwordx4 v18, s[32:35], s19 offen lds
    s_add_u32 m0, s18, 4096
    s_mov_b32 s19, 32768
    buffer_load_dwordx4 v18, s[32:35], s19 offen lds
    s_add_u32 m0, s18, 8192
    s_mov_b32 s19, 65536
    buffer_load_dwordx4 v18, s[32:35], s19 offen lds
    s_add_u32 m0, s18, 12288
    s_mov_b32 s19, 98304
    buffer_load_dwordx4 v18, s[32:35], s19 offen lds
    s_add_u32 m0, s18, 16384
    s_mov_b32 s19, 131072
    buffer_load_dwordx4 v18, s[32:35], s19 offen lds
    s_add_u32 m0, s18, 20480
    s_mov_b32 s19, 163840
    buffer_load_dwordx4 v18, s[32:35], s19 offen lds
    s_add_u32 m0, s18, 24576
    s_mov_b32 s19, 196608
    buffer_load_dwordx4 v18, s[32:35], s19 offen lds
    s_add_u32 m0, s18, 28672
    s_mov_b32 s19, 229376
    buffer_load_dwordx4 v18, s[32:35], s19 offen lds
    s_add_u32 m0, s18, 32768
    s_mov_b32 s19, 262144
    buffer_load_dwordx4 v18, s[32:35], s19 offen lds
    s_add_u32 m0, s18, 36864
    s_mov_b32 s19, 294912
    buffer_load_dwordx4 v18, s[32:35], s19 offen lds
    s_waitcnt vmcnt(20)
    s_barrier
    s_add_u32 m0, s18, 40960
    s_mov_b32 s19, 688128
    buffer_load_dwordx4 v18, s[32:35], s19 offen lds
    s_add_u32 m0, s18, 45056
    s_mov_b32 s19, 393216
    buffer_load_dwordx4 v18, s[32:35], s19 offen lds
    s_add_u32 m0, s18, 49152
    s_mov_b32 s19, 425984
    buffer_load_dwordx4 v18, s[32:35], s19 offen lds
    s_add_u32 m0, s18, 53248
    s_mov_b32 s19, 458752
    buffer_load_dwordx4 v18, s[32:35], s19 offen lds
    s_add_u32 m0, s18, 57344
    s_mov_b32 s19, 491520
    buffer_load_dwordx4 v18, s[32:35], s19 offen lds
    s_add_u32 m0, s18, 61440
    s_mov_b32 s19, 524288
    buffer_load_dwordx4 v18, s[32:35], s19 offen lds
    s_add_u32 m0, s18, 65536
    s_mov_b32 s19, 557056
    buffer_load_dwordx4 v18, s[32:35], s19 offen lds
    s_add_u32 m0, s18, 69632
    s_mov_b32 s19, 589824
    buffer_load_dwordx4 v18, s[32:35], s19 offen lds
    s_add_u32 m0, s18, 73728
    s_mov_b32 s19, 622592
    buffer_load_dwordx4 v18, s[32:35], s19 offen lds
    s_add_u32 m0, s18, 77824
    s_mov_b32 s19, 655360
    buffer_load_dwordx4 v18, s[32:35], s19 offen lds
    s_waitcnt vmcnt(20)
    s_barrier
    s_barrier
    s_barrier
    s_add_u32 m0, s18, 81920
    s_mov_b32 s19, 1048576
    buffer_load_dwordx4 v18, s[32:35], s19 offen lds
    s_add_u32 m0, s18, 86016
    s_mov_b32 s19, 753664
    buffer_load_dwordx4 v18, s[32:35], s19 offen lds
    s_add_u32 m0, s18, 126976
    s_mov_b32 s19, 1114112
    buffer_load_dwordx4 v18, s[32:35], s19 offen lds
    s_add_u32 m0, s18, 90112
    s_mov_b32 s19, 786432
    buffer_load_dwordx4 v18, s[32:35], s19 offen lds
    s_add_u32 m0, s18, 131072
    s_mov_b32 s19, 1146880
    buffer_load_dwordx4 v18, s[32:35], s19 offen lds
    s_add_u32 m0, s18, 94208
    s_mov_b32 s19, 819200
    buffer_load_dwordx4 v18, s[32:35], s19 offen lds
    s_add_u32 m0, s18, 135168
    s_mov_b32 s19, 1179648
    buffer_load_dwordx4 v18, s[32:35], s19 offen lds
    s_add_u32 m0, s18, 98304
    s_mov_b32 s19, 851968
    buffer_load_dwordx4 v18, s[32:35], s19 offen lds
    s_add_u32 m0, s18, 139264
    s_mov_b32 s19, 1212416
    buffer_load_dwordx4 v18, s[32:35], s19 offen lds
    s_add_u32 m0, s18, 102400
    s_mov_b32 s19, 884736
    buffer_load_dwordx4 v18, s[32:35], s19 offen lds
    s_waitcnt vmcnt(9)
    s_branch LD_e
LD_nop1:
    s_add_u32 m0, s18, 0
    s_mov_b32 s19, 327680
    buffer_load_dwordx4 v18, s[32:35], s19 offen lds
    s_add_u32 m0, s18, 4096
    s_mov_b32 s19, 32768
    buffer_load_dwordx4 v18, s[32:35], s19 offen lds
    s_add_u32 m0, s18, 8192
    s_mov_b32 s19, 65536
    buffer_load_dwordx4 v18, s[32:35], s19 offen lds
    s_add_u32 m0, s18, 12288
    s_mov_b32 s19, 98304
    buffer_load_dwordx4 v18, s[32:35], s19 offen lds
    s_add_u32 m0, s18, 16384
    s_mov_b32 s19, 131072
    buffer_load_dwordx4 v18, s[32:35], s19 offen lds
    s_add_u32 m0, s18, 20480
    s_mov_b32 s19, 163840
    buffer_load_dwordx4 v18, s[32:35], s19 offen lds
    s_add_u32 m0, s18, 24576
    s_mov_b32 s19, 196608
    buffer_load_dwordx4 v18, s[32:35], s19 offen lds
    s_add_u32 m0, s18, 28672
    s_mov_b32 s19, 229376
    buffer_load_dwordx4 v18, s[32:35], s19 offen lds
    s_add_u32 m0, s18, 32768
    s_mov_b32 s19, 262144
    buffer_load_dwordx4 v18, s[32:35], s19 offen lds
    s_add_u32 m0, s18, 36864
    s_mov_b32 s19, 294912
    buffer_load_dwordx4 v18, s[32:35], s19 offen lds
    s_add_u32 m0, s18, 40960
    s_mov_b32 s19, 688128
    buffer_load_dwordx4 v18, s[32:35], s19 offen lds
    s_add_u32 m0, s18, 45056
    s_mov_b32 s19, 393216
    buffer_load_dwordx4 v18, s[32:35], s19 offen lds
    s_add_u32 m0, s18, 49152
    s_mov_b32 s19, 425984
    buffer_load_dwordx4 v18, s[32:35], s19 offen lds
    s_add_u32 m0, s18, 53248
    s_mov_b32 s19, 458752
    buffer_load_dwordx4 v18, s[32:35], s19 offen lds
    s_add_u32 m0, s18, 57344
    s_mov_b32 s19, 491520
    buffer_load_dwordx4 v18, s[32:35], s19 offen lds
    s_add_u32 m0, s18, 61440
    s_mov_b32 s19, 524288
    buffer_load_dwordx4 v18, s[32:35], s19 offen lds
    s_add_u32 m0, s18, 65536
    s_mov_b32 s19, 557056
    buffer_load_dwordx4 v18, s[32:35], s19 offen lds
    s_add_u32 m0, s18, 69632
    s_mov_b32 s19, 589824
    buffer_load_dwordx4 v18, s[32:35], s19 offen lds
    s_add_u32 m0, s18, 73728
    s_mov_b32 s19, 622592
    buffer_load_dwordx4 v18, s[32:35], s19 offen lds
    s_add_u32 m0, s18, 77824
    s_mov_b32 s19, 655360
    buffer_load_dwordx4 v18, s[32:35], s19 offen lds
    s_add_u32 m0, s18, 81920
    s_mov_b32 s19, 1048576
    buffer_load_dwordx4 v18, s[32:35], s19 offen lds
    s_add_u32 m0, s18, 86016
    s_mov_b32 s19, 753664
    buffer_load_dwordx4 v18, s[32:35], s19 offen lds
    s_add_u32 m0, s18, 126976
    s_mov_b32 s19, 1114112
    buffer_load_dwordx4 v18, s[32:35], s19 offen lds
    s_add_u32 m0, s18, 90112
    s_mov_b32 s19, 786432
    buffer_load_dwordx4 v18, s[32:35], s19 offen lds
    s_add_u32 m0, s18, 131072
    s_mov_b32 s19, 1146880
    buffer_load_dwordx4 v18, s[32:35], s19 offen lds
    s_add_u32 m0, s18, 94208
    s_mov_b32 s19, 819200
    buffer_load_dwordx4 v18, s[32:35], s19 offen lds
    s_add_u32 m0, s18, 135168
    s_mov_b32 s19, 1179648
    buffer_load_dwordx4 v18, s[32:35], s19 offen lds
    s_add_u32 m0, s18, 98304
    s_mov_b32 s19, 851968
    buffer_load_dwordx4 v18, s[32:35], s19 offen lds
    s_add_u32 m0, s18, 139264
    s_mov_b32 s19, 1212416
    buffer_load_dwordx4 v18, s[32:35], s19 offen lds
    s_add_u32 m0, s18, 102400
    s_mov_b32 s19, 884736
    buffer_load_dwordx4 v18, s[32:35], s19 offen lds
    s_waitcnt vmcnt(9)
LD_e:
    s_barrier
    s_add_u32 m0, s18, 143360
    s_mov_b32 s19, 1245184
    buffer_load_dwordx4 v18, s[32:35], s19 offen lds
    s_add_u32 m0, s18, 106496
    s_mov_b32 s19, 917504
    buffer_load_dwordx4 v18, s[32:35], s19 offen lds
    s_add_u32 m0, s18, 147456
    s_mov_b32 s19, 1277952
    buffer_load_dwordx4 v18, s[32:35], s19 offen lds
    s_add_u32 m0, s18, 110592
    s_mov_b32 s19, 950272
    buffer_load_dwordx4 v18, s[32:35], s19 offen lds
    s_add_u32 m0, s18, 151552
    s_mov_b32 s19, 1310720
    buffer_load_dwordx4 v18, s[32:35], s19 offen lds
    s_add_u32 m0, s18, 114688
    s_mov_b32 s19, 983040
    buffer_load_dwordx4 v18, s[32:35], s19 offen lds
    s_add_u32 m0, s18, 155648
    s_mov_b32 s19, 1343488
    buffer_load_dwordx4 v18, s[32:35], s19 offen lds
    s_add_u32 m0, s18, 118784
    s_mov_b32 s19, 1015808
    buffer_load_dwordx4 v18, s[32:35], s19 offen lds
    s_add_u32 m0, s18, 159744
    s_mov_b32 s19, 1376256
    buffer_load_dwordx4 v18, s[32:35], s19 offen lds
    s_add_u32 m0, s18, 122880
    s_mov_b32 s19, 1081344
    buffer_load_dwordx4 v18, s[32:35], s19 offen lds
    s_mov_b32 s36, s12
    s_and_b32 s37, s13, 0xffff
    s_mov_b32 s38, 2097152
    s_mov_b32 s39, 0x00020000
    s_and_b32 s56, s50, 3
    s_lshr_b32 s57, s50, 2
    s_lshl_b32 s58, s51, 1
    s_add_u32 s59, s58, s57
    s_mul_i32 s59, s59, 86
    s_mul_i32 s61, s56, 22
    s_add_u32 s59, s59, s61
    s_lshl_b32 s59, s59, 10
    v_lshlrev_b32 v3, 4, v1
    v_add_u32 v24, s59, v3
    s_mul_i32 s62, s56, 40960
    s_cmp_eq_u32 s56, 3
    s_cselect_b32 s63, 0, 20480
    s_and_b32 s58, s56, 1
    s_lshr_b32 s59, s56, 1
    v_lshrrev_b32 v3, 5, v1
    v_bfe_u32 v4, v1, 2, 2
    v_lshl_add_u32 v3, v3, 2, v4
    v_lshlrev_b32 v3, 7, v3
    v_bfe_u32 v4, v1, 3, 1
    v_xor_b32 v4, s58, v4
    v_lshl_add_u32 v3, v4, 6, v3
    v_bfe_u32 v4, v1, 4, 1
    v_xor_b32 v4, s59, v4
    v_lshl_add_u32 v3, v4, 5, v3
    v_and_b32 v4, 3, v1
    v_lshl_add_u32 v3, v4, 3, v3
    v_add_u32 v26, s62, v3
    v_xor_b32 v27, 64, v26
    ds_read_b64_tr_b16 v[208:209], v26 offset:0
    ds_read_b64_tr_b16 v[210:211], v26 offset:1024
    ds_read_b64_tr_b16 v[212:213], v27 offset:0
    ds_read_b64_tr_b16 v[214:215], v27 offset:1024
    ds_read_b64_tr_b16 v[216:217], v26 offset:2048
    ds_read_b64_tr_b16 v[218:219], v26 offset:3072
    ds_read_b64_tr_b16 v[220:221], v27 offset:2048
    ds_read_b64_tr_b16 v[222:223], v27 offset:3072
    s_waitcnt lgkmcnt(0)
    s_cmp_lg_u32 s56, 3
    s_cbranch_scc1 P2S_2
    v_mov_b32 v208, 0
    v_mov_b32 v209, 0
    v_mov_b32 v210, 0
    v_mov_b32 v211, 0
    v_mov_b32 v212, 0
    v_mov_b32 v213, 0
    v_mov_b32 v214, 0
    v_mov_b32 v215, 0
    v_mov_b32 v216, 0
    v_mov_b32 v217, 0
    v_mov_b32 v218, 0
    v_mov_b32 v219, 0
    v_mov_b32 v220, 0
    v_mov_b32 v221, 0
    v_mov_b32 v222, 0
    v_mov_b32 v223, 0
P2S_2:
    s_barrier
    s_add_u32 m0, s18, 0
    s_mov_b32 s19, 0
    buffer_load_dwordx4 v18, s[32:35], s19 offen lds
    s_add_u32 m0, s18, 40960
    s_mov_b32 s19, 360448
    buffer_load_dwordx4 v18, s[32:35], s19 offen lds
    s_add_u32 m0, s18, 81920
    s_mov_b32 s19, 720896
    buffer_load_dwordx4 v18, s[32:35], s19 offen lds
    s_waitcnt vmcnt(3)
P2_main:
    s_barrier
    buffer_load_dwordx4 v[88:91], v24, s[40:43], s63 offen offset:0 sc1
    buffer_load_dwordx4 v[92:95], v24, s[40:43], s63 offen offset:1024 sc1
    s_mov_b32 s58, 2048
    buffer_load_dwordx4 v[96:99], v24, s[40:43], s58 offen offset:0 sc1
    buffer_load_dwordx4 v[100:103], v24, s[40:43], s58 offen offset:1024 sc1
    s_mov_b32 s58, 4096
    buffer_load_dwordx4 v[104:107], v24, s[40:43], s58 offen offset:0 sc1
    buffer_load_dwordx4 v[108:111], v24, s[40:43], s58 offen offset:1024 sc1
    s_mov_b32 s58, 6144
    buffer_load_dwordx4 v[112:115], v24, s[40:43], s58 offen offset:0 sc1
    buffer_load_dwordx4 v[116:119], v24, s[40:43], s58 offen offset:1024 sc1
    s_waitcnt vmcnt(6)
    v_mfma_f32_32x32x16_bf16 v[224:239], v[208:211], v[88:91], 0
    ds_read_b64_tr_b16 v[192:193], v26 offset:4096
    ds_read_b64_tr_b16 v[194:195], v26 offset:5120
    v_mfma_f32_32x32x16_bf16 v[240:255], v[212:215], v[88:91], 0
    ds_read_b64_tr_b16 v[196:197], v27 offset:4096
    ds_read_b64_tr_b16 v[198:199], v27 offset:5120
    s_mov_b32 s58, 8192
    buffer_load_dwordx4 v[120:123], v24, s[40:43], s58 offen offset:0 sc1
    buffer_load_dwordx4 v[124:127], v24, s[40:43], s58 offen offset:1024 sc1
    v_mfma_f32_32x32x16_bf16 v[224:239], v[216:219], v[92:95], v[224:239]
    ds_read_b64_tr_b16 v[200:201], v26 offset:6144
    ds_read_b64_tr_b16 v[202:203], v26 offset:7168
    v_mfma_f32_32x32x16_bf16 v[240:255], v[220:223], v[92:95], v[240:255]
    ds_read_b64_tr_b16 v[204:205], v27 offset:6144
    ds_read_b64_tr_b16 v[206:207], v27 offset:7168
    s_waitcnt vmcnt(6)
    s_waitcnt lgkmcnt(6)
    v_mfma_f32_32x32x16_bf16 v[224:239], v[192:195], v[96:99], v[224:239]
    ds_read_b64_tr_b16 v[176:177], v26 offset:8192
    ds_read_b64_tr_b16 v[178:179], v26 offset:9216
    s_waitcnt lgkmcnt(6)
    v_mfma_f32_32x32x16_bf16 v[240:255], v[196:199], v[96:99], v[240:255]
    ds_read_b64_tr_b16 v[180:181], v27 offset:8192
    ds_read_b64_tr_b16 v[182:183], v27 offset:9216
    s_mov_b32 s58, 10240
    buffer_load_dwordx4 v[128:131], v24, s[40:43], s58 offen offset:0 sc1
    buffer_load_dwordx4 v[132:135], v24, s[40:43], s58 offen offset:1024 sc1
    s_waitcnt lgkmcnt(6)
    v_mfma_f32_32x32x16_bf16 v[224:239], v[200:203], v[100:103], v[224:239]
    ds_read_b64_tr_b16 v[184:185], v26 offset:10240
    ds_read_b64_tr_b16 v[186:187], v26 offset:11264
    s_waitcnt lgkmcnt(6)
    v_mfma_f32_32x32x16_bf16 v[240:255], v[204:207], v[100:103], v[240:255]
    ds_read_b64_tr_b16 v[188:189], v27 offset:10240
    ds_read_b64_tr_b16 v[190:191], v27 offset:11264
    s_waitcnt vmcnt(6)
    s_waitcnt lgkmcnt(6)
    v_mfma_f32_32x32x16_bf16 v[224:239], v[176:179], v[104:107], v[224:239]
    ds_read_b64_tr_b16 v[192:193], v26 offset:12288
    ds_read_b64_tr_b16 v[194:195], v26 offset:13312
    s_waitcnt lgkmcnt(6)
    v_mfma_f32_32x32x16_bf16 v[240:255], v[180:183], v[104:107], v[240:255]
    ds_read_b64_tr_b16 v[196:197], v27 offset:12288
    ds_read_b64_tr_b16 v[198:199], v27 offset:13312
    s_mov_b32 s58, 12288
    buffer_load_dwordx4 v[136:139], v24, s[40:43], s58 offen offset:0 sc1
    buffer_load_dwordx4 v[140:143], v24, s[40:43], s58 offen offset:1024 sc1
    s_waitcnt lgkmcnt(6)
    v_mfma_f32_32x32x16_bf16 v[224:239], v[184:187], v[108:111], v[224:239]
    ds_read_b64_tr_b16 v[200:201], v26 offset:14336
    ds_read_b64_tr_b16 v[202:203], v26 offset:15360
    s_waitcnt lgkmcnt(6)
    v_mfma_f32_32x32x16_bf16 v[240:255], v[188:191], v[108:111], v[240:255]
    ds_read_b64_tr_b16 v[204:205], v27 offset:14336
    ds_read_b64_tr_b16 v[206:207], v27 offset:15360
    s_waitcnt vmcnt(6)
    s_waitcnt lgkmcnt(6)
    v_mfma_f32_32x32x16_bf16 v[224:239], v[192:195], v[112:115], v[224:239]
    ds_read_b64_tr_b16 v[176:177], v26 offset:16384
    ds_read_b64_tr_b16 v[178:179], v26 offset:17408
    s_waitcnt lgkmcnt(6)
    v_mfma_f32_32x32x16_bf16 v[240:255], v[196:199], v[112:115], v[240:255]
    ds_read_b64_tr_b16 v[180:181], v27 offset:16384
    ds_read_b64_tr_b16 v[182:183], v27 offset:17408
    s_mov_b32 s58, 14336
    buffer_load_dwordx4 v[144:147], v24, s[40:43], s58 offen offset:0 sc1
    buffer_load_dwordx4 v[148:151], v24, s[40:43], s58 offen offset:1024 sc1
    s_waitcnt lgkmcnt(6)
    v_mfma_f32_32x32x16_bf16 v[224:239], v[200:203], v[116:119], v[224:239]
    ds_read_b64_tr_b16 v[184:185], v26 offset:18432
    ds_read_b64_tr_b16 v[186:187], v26 offset:19456
    s_waitcnt lgkmcnt(6)
    v_mfma_f32_32x32x16_bf16 v[240:255], v[204:207], v[116:119], v[240:255]
    ds_read_b64_tr_b16 v[188:189], v27 offset:18432
    ds_read_b64_tr_b16 v[190:191], v27 offset:19456
    s_waitcnt vmcnt(6)
    s_waitcnt lgkmcnt(6)
    v_mfma_f32_32x32x16_bf16 v[224:239], v[176:179], v[120:123], v[224:239]
    ds_read_b64_tr_b16 v[192:193], v26 offset:20480
    ds_read_b64_tr_b16 v[194:195], v26 offset:21504
    s_waitcnt lgkmcnt(6)
    v_mfma_f32_32x32x16_bf16 v[240:255], v[180:183], v[120:123], v[240:255]
    ds_read_b64_tr_b16 v[196:197], v27 offset:20480
    ds_read_b64_tr_b16 v[198:199], v27 offset:21504
    s_mov_b32 s58, 16384
    buffer_load_dwordx4 v[152:155], v24, s[40:43], s58 offen offset:0 sc1
    buffer_load_dwordx4 v[156:159], v24, s[40:43], s58 offen offset:1024 sc1
    s_waitcnt lgkmcnt(6)
    v_mfma_f32_32x32x16_bf16 v[224:239], v[184:187], v[124:127], v[224:239]
    ds_read_b64_tr_b16 v[200:201], v26 offset:22528
    ds_read_b64_tr_b16 v[202:203], v26 offset:23552
    s_waitcnt lgkmcnt(6)
    v_mfma_f32_32x32x16_bf16 v[240:255], v[188:191], v[124:127], v[240:255]
    ds_read_b64_tr_b16 v[204:205], v27 offset:22528
    ds_read_b64_tr_b16 v[206:207], v27 offset:23552
    s_waitcnt vmcnt(6)
    s_waitcnt lgkmcnt(6)
    v_mfma_f32_32x32x16_bf16 v[224:239], v[192:195], v[128:131], v[224:239]
    ds_read_b64_tr_b16 v[176:177], v26 offset:24576
    ds_read_b64_tr_b16 v[178:179], v26 offset:25600
    s_waitcnt lgkmcnt(6)
    v_mfma_f32_32x32x16_bf16 v[240:255], v[196:199], v[128:131], v[240:255]
    ds_read_b64_tr_b16 v[180:181], v27 offset:24576
    ds_read_b64_tr_b16 v[182:183], v27 offset:25600
    s_mov_b32 s58, 18432
    buffer_load_dwordx4 v[160:163], v24, s[40:43], s58 offen offset:0 sc1
    buffer_load_dwordx4 v[164:167], v24, s[40:43], s58 offen offset:1024 sc1
    s_waitcnt lgkmcnt(6)
    v_mfma_f32_32x32x16_bf16 v[224:239], v[200:203], v[132:135], v[224:239]
    ds_read_b64_tr_b16 v[184:185], v26 offset:26624
    ds_read_b64_tr_b16 v[186:187], v26 offset:27648
    s_waitcnt lgkmcnt(6)
    v_mfma_f32_32x32x16_bf16 v[240:255], v[204:207], v[132:135], v[240:255]
    ds_read_b64_tr_b16 v[188:189], v27 offset:26624
    ds_read_b64_tr_b16 v[190:191], v27 offset:27648
    s_waitcnt vmcnt(6)
    s_waitcnt lgkmcnt(6)
    v_mfma_f32_32x32x16_bf16 v[224:239], v[176:179], v[136:139], v[224:239]
    ds_read_b64_tr_b16 v[192:193], v26 offset:28672
    ds_read_b64_tr_b16 v[194:195], v26 offset:29696
    s_waitcnt lgkmcnt(6)
    v_mfma_f32_32x32x16_bf16 v[240:255], v[180:183], v[136:139], v[240:255]
    ds_read_b64_tr_b16 v[196:197], v27 offset:28672
    ds_read_b64_tr_b16 v[198:199], v27 offset:29696
    buffer_load_dwordx4 v[168:171], v24, s[40:43], 0 offen offset:0 sc1
    buffer_load_dwordx4 v[172:175], v24, s[40:43], 0 offen offset:1024 sc1
    s_waitcnt lgkmcnt(6)
    v_mfma_f32_32x32x16_bf16 v[224:239], v[184:187], v[140:143], v[224:239]
    ds_read_b64_tr_b16 v[200:201], v26 offset:30720
    ds_read_b64_tr_b16 v[202:203], v26 offset:31744
    s_waitcnt lgkmcnt(6)
    v_mfma_f32_32x32x16_bf16 v[240:255], v[188:191], v[140:143], v[240:255]
    ds_read_b64_tr_b16 v[204:205], v27 offset:30720
    ds_read_b64_tr_b16 v[206:207], v27 offset:31744
    s_waitcnt vmcnt(6)
    s_waitcnt lgkmcnt(6)
    v_mfma_f32_32x32x16_bf16 v[224:239], v[192:195], v[144:147], v[224:239]
    ds_read_b64_tr_b16 v[176:177], v26 offset:32768
    ds_read_b64_tr_b16 v[178:179], v26 offset:33792
    s_waitcnt lgkmcnt(6)
    v_mfma_f32_32x32x16_bf16 v[240:255], v[196:199], v[144:147], v[240:255]
    ds_read_b64_tr_b16 v[180:181], v27 offset:32768
    ds_read_b64_tr_b16 v[182:183], v27 offset:33792
    s_waitcnt lgkmcnt(6)
    v_mfma_f32_32x32x16_bf16 v[224:239], v[200:203], v[148:151], v[224:239]
    ds_read_b64_tr_b16 v[184:185], v26 offset:34816
    ds_read_b64_tr_b16 v[186:187], v26 offset:35840
    s_waitcnt lgkmcnt(6)
    v_mfma_f32_32x32x16_bf16 v[240:255], v[204:207], v[148:151], v[240:255]
    ds_read_b64_tr_b16 v[188:189], v27 offset:34816
    ds_read_b64_tr_b16 v[190:191], v27 offset:35840
    s_barrier
    s_waitcnt vmcnt(4)
    s_waitcnt lgkmcnt(6)
    v_mfma_f32_32x32x16_bf16 v[224:239], v[176:179], v[152:155], v[224:239]
    ds_read_b64_tr_b16 v[192:193], v26 offset:36864
    ds_read_b64_tr_b16 v[194:195], v26 offset:37888
    s_waitcnt lgkmcnt(6)
    v_mfma_f32_32x32x16_bf16 v[240:255], v[180:183], v[152:155], v[240:255]
    ds_read_b64_tr_b16 v[196:197], v27 offset:36864
    ds_read_b64_tr_b16 v[198:199], v27 offset:37888
    s_waitcnt lgkmcnt(6)
    v_mfma_f32_32x32x16_bf16 v[224:239], v[184:187], v[156:159], v[224:239]
    ds_read_b64_tr_b16 v[200:201], v26 offset:38912
    ds_read_b64_tr_b16 v[202:203], v26 offset:39936
    s_waitcnt lgkmcnt(6)
    v_mfma_f32_32x32x16_bf16 v[240:255], v[188:191], v[156:159], v[240:255]
    ds_read_b64_tr_b16 v[204:205], v27 offset:38912
    ds_read_b64_tr_b16 v[206:207], v27 offset:39936
    s_waitcnt vmcnt(2)
    s_waitcnt lgkmcnt(6)
    v_mfma_f32_32x32x16_bf16 v[224:239], v[192:195], v[160:163], v[224:239]
    ds_read_b64_tr_b16 v[176:177], v26 offset:0
    ds_read_b64_tr_b16 v[178:179], v26 offset:1024
    s_waitcnt lgkmcnt(6)
    v_mfma_f32_32x32x16_bf16 v[240:255], v[196:199], v[160:163], v[240:255]
    ds_read_b64_tr_b16 v[180:181], v27 offset:0
    ds_read_b64_tr_b16 v[182:183], v27 offset:1024
    s_waitcnt lgkmcnt(6)
    v_mfma_f32_32x32x16_bf16 v[224:239], v[200:203], v[164:167], v[224:239]
    ds_read_b64_tr_b16 v[184:185], v26 offset:2048
    ds_read_b64_tr_b16 v[186:187], v26 offset:3072
    s_waitcnt lgkmcnt(6)
    v_mfma_f32_32x32x16_bf16 v[240:255], v[204:207], v[164:167], v[240:255]
    ds_read_b64_tr_b16 v[188:189], v27 offset:2048
    ds_read_b64_tr_b16 v[190:191], v27 offset:3072
    s_waitcnt vmcnt(0)
    s_waitcnt lgkmcnt(6)
    v_mfma_f32_32x32x16_bf16 v[224:239], v[176:179], v[168:171], v[224:239]
    s_waitcnt lgkmcnt(4)
    v_mfma_f32_32x32x16_bf16 v[240:255], v[180:183], v[168:171], v[240:255]
    s_waitcnt lgkmcnt(2)
    v_mfma_f32_32x32x16_bf16 v[224:239], v[184:187], v[172:175], v[224:239]
    s_waitcnt lgkmcnt(0)
    v_mfma_f32_32x32x16_bf16 v[240:255], v[188:191], v[172:175], v[240:255]
    v_lshlrev_b32 v3, 4, v1
    s_mul_i32 s58, s57, 6144
    s_add_u32 s58, s58, 4096
    v_add_u32 v3, s58, v3
    v_add_u32 v4, s62, v3
    s_xor_b32 s58, s56, 1
    s_mul_i32 s58, s58, 40960
    v_add_u32 v5, s58, v3
    s_xor_b32 s58, s56, 2
    s_mul_i32 s58, s58, 40960
    v_add_u32 v6, s58, v3
    s_xor_b32 s58, s56, 3
    s_mul_i32 s58, s58, 40960
    v_add_u32 v7, s58, v3
    s_nop 7
    ds_write_b128 v4, v[240:243] offset:0
    ds_write_b128 v4, v[244:247] offset:1024
    ds_write_b128 v4, v[232:235] offset:2048
    ds_write_b128 v4, v[236:239] offset:3072
    ds_write_b128 v4, v[248:251] offset:4096
    ds_write_b128 v4, v[252:255] offset:5120
    s_waitcnt lgkmcnt(0)
    s_barrier
    ds_read_b128 v[64:67], v5 offset:0
    ds_read_b128 v[68:71], v5 offset:1024
    ds_read_b128 v[72:75], v6 offset:2048
    ds_read_b128 v[76:79], v6 offset:3072
    ds_read_b128 v[80:83], v7 offset:4096
    ds_read_b128 v[84:87], v7 offset:5120
    s_lshl_b32 s58, s51, 6
    s_lshl_b32 s59, s57, 5
    s_add_u32 s58, s58, s59
    v_and_b32 v3, 31, v1
    v_add_u32 v3, s58, v3
    v_lshlrev_b32 v3, 10, v3
    s_lshl_b32 s58, s52, 7
    s_and_b32 s59, s56, 1
    s_lshl_b32 s59, s59, 6
    s_add_u32 s58, s58, s59
    s_lshr_b32 s59, s56, 1
    s_lshl_b32 s59, s59, 5
    s_add_u32 s58, s58, s59
    v_add_u32 v3, s58, v3
    v_lshrrev_b32 v8, 5, v1
    v_lshl_add_u32 v3, v8, 4, v3
    s_waitcnt lgkmcnt(4)
    v_add_f32 v224, v224, v64
    v_add_f32 v225, v225, v65
    v_add_f32 v226, v226, v66
    v_add_f32 v227, v227, v67
    v_add_f32 v228, v228, v68
    v_add_f32 v229, v229, v69
    v_add_f32 v230, v230, v70
    v_add_f32 v231, v231, v71
    s_waitcnt lgkmcnt(2)
    v_add_f32 v224, v224, v72
    v_add_f32 v225, v225, v73
    v_add_f32 v226, v226, v74
    v_add_f32 v227, v227, v75
    v_add_f32 v228, v228, v76
    v_add_f32 v229, v229, v77
    v_add_f32 v230, v230, v78
    v_add_f32 v231, v231, v79
    s_waitcnt lgkmcnt(0)
    v_add_f32 v224, v224, v80
    v_add_f32 v225, v225, v81
    v_add_f32 v226, v226, v82
    v_add_f32 v227, v227, v83
    v_add_f32 v228, v228, v84
    v_add_f32 v229, v229, v85
    v_add_f32 v230, v230, v86
    v_add_f32 v231, v231, v87
    v_cvt_pk_bf16_f32 v32, v224, v225
    v_cvt_pk_bf16_f32 v33, v226, v227
    v_cvt_pk_bf16_f32 v34, v228, v229
    v_cvt_pk_bf16_f32 v35, v230, v231
    s_nop 1
    v_permlane32_swap_b32 v32, v34
    v_permlane32_swap_b32 v33, v35
    buffer_store_dwordx4 v[32:35], v3, s[36:39], 0 offen
L_end:
    s_endpgm
.section .rodata,"a"
.p2align 6
.amdhsa_kernel standalone__swiglu_ffn__prompt_kernel
  .amdhsa_next_free_vgpr 256
  .amdhsa_next_free_sgpr 102
  .amdhsa_accum_offset 256
  .amdhsa_group_segment_fixed_size 0
  .amdhsa_kernarg_size 56
  .amdhsa_user_sgpr_count 2
  .amdhsa_user_sgpr_kernarg_segment_ptr 1
  .amdhsa_system_sgpr_workgroup_id_x 1
.end_amdhsa_kernel
```
